```python
import torch

def _softmax(x, axis=-1):
    return torch.softmax(x, dim=axis)

def _gelu(x):
    return torch.nn.functional.gelu(x, approximate='tanh')

def _silu(x):
    return torch.nn.functional.silu(x)

def _sigmoid(x):
    return torch.sigmoid(x)

def _layernorm(x, axis=-1, eps=1e-05):
    m = x.mean(dim=axis, keepdim=True)
    v = x.var(dim=axis, keepdim=True, unbiased=False)
    return (x - m) / torch.sqrt(v + eps)

def _scatter_add(tgt, idx, src, axis=0):
    return tgt.clone().index_add_(axis, idx, src)

def _segment_sum(src, seg, n):
    out = torch.zeros((n,) + src.shape[1:], dtype=src.dtype)
    return out.index_add_(0, seg, src)

def _pad(x, pw):
    flat = tuple((v for pair in reversed(pw) for v in pair))
    return torch.nn.functional.pad(x, flat)
kernel_name = 'adaLN_cond__ssm_conv_s4__glu_gated_bilinear__prompt'

def setup_inputs():

    _w = lambda a: (lambda t: t.to(torch.bfloat16) if t.is_floating_point() else t)(torch.as_tensor(a))

    def _A_setup():
        B, L, D, N = (1, 2048, 512, 128)
        A_re = -(lambda _x: torch.exp(torch.as_tensor(_x)))((lambda *s: torch.randn(*s, dtype=torch.bfloat16) * 3.2)(D, N))
        A_im = torch.pi * (lambda *s: torch.randn(*s, dtype=torch.bfloat16) * 0.1)(D, N)
        B_re = (lambda *s: torch.randn(*s, dtype=torch.bfloat16) * 0.1)(D, N)
        B_im = (lambda *s: torch.randn(*s, dtype=torch.bfloat16) * 0.1)(D, N)
        C_re = (lambda *s: torch.randn(*s, dtype=torch.bfloat16) * 0.1)(D, N)
        C_im = (lambda *s: torch.randn(*s, dtype=torch.bfloat16) * 0.1)(D, N)
        log_dt = (lambda *s: torch.randn(*s, dtype=torch.bfloat16) * 0.1)(D) * 0.5 - 4.0
        Dskip = (lambda *s: torch.randn(*s, dtype=torch.bfloat16) * 0.1)(D)
        return {'u': _w((lambda *s: torch.randn(*s, dtype=torch.bfloat16) * 0.05)(B, L, D)), 'A_re': _w(A_re), 'A_im': _w(A_im), 'B_re': _w(B_re), 'B_im': _w(B_im), 'C_re': _w(C_re), 'C_im': _w(C_im), 'log_dt': _w(log_dt), 'Dskip': _w(Dskip)}
    _A_in = _A_setup()

    def _B_setup():
        B, S, D, F = (1, 2048, 512, 1792)
        return {'x': _w((lambda *s: torch.randn(*s, dtype=torch.bfloat16) * 0.05)(B, S, D)), 'w_gate': _w((lambda *s: torch.randn(*s, dtype=torch.bfloat16) * 1.6)(D, F) * D ** (-0.5)), 'w_up': _w((lambda *s: torch.randn(*s, dtype=torch.bfloat16) * 1.6)(D, F) * D ** (-0.5)), 'w_down': _w((lambda *s: torch.randn(*s, dtype=torch.bfloat16) * 1.6)(F, D) * F ** (-0.5))}
    _B_in = _B_setup()
    return {'A_u': _A_in['u'], 'A_A_re': _A_in['A_re'], 'A_A_im': _A_in['A_im'], 'A_B_re': _A_in['B_re'], 'A_B_im': _A_in['B_im'], 'A_C_re': _A_in['C_re'], 'A_C_im': _A_in['C_im'], 'A_log_dt': _A_in['log_dt'], 'A_Dskip': _A_in['Dskip'], 'B_x': _B_in['x'], 'B_w_gate': _B_in['w_gate'], 'B_w_up': _B_in['w_up'], 'B_w_down': _B_in['w_down'], 'c': _w((lambda *s: torch.randn(*s, dtype=torch.bfloat16) * 0.2)(1, 512) * 8.0), 'w_mod': _w((lambda *s: torch.randn(*s, dtype=torch.bfloat16) * 0.2)(512, 6 * 512) * 512 ** (-0.5) * 8.0)}

def reference(A_u, A_A_re, A_A_im, A_B_re, A_B_im, A_C_re, A_C_im, A_log_dt, A_Dskip, B_x, B_w_gate, B_w_up, B_w_down, c, w_mod):

    def _A_ref(u, A_re, A_im, B_re, B_im, C_re, C_im, log_dt, Dskip):
        Bsz, L, D = u.shape
        dt = torch.exp(log_dt)[:, None]
        A = A_re + 1j * A_im
        Bc = B_re + 1j * B_im
        Cc = C_re + 1j * C_im
        logdA = dt * A
        dB = dt * Bc
        l = (lambda x, dt: x.to(dt))(torch.arange(L), A_re.dtype)
        P = torch.exp(logdA[:, :, None] * l[None, None, :])
        K = torch.einsum('dn,dnl,dn->dl', Cc, P, dB).real
        L2 = 2 * L
        Kp = _pad(K, ((0, 0), (0, L)))
        up = (lambda x, *d: x.permute(*d))(u, 0, 2, 1)
        up = _pad(up, ((0, 0), (0, 0), (0, L)))
        Kf = (lambda x, axes=(-2, -1): torch.fft.rfft2(x.float(), dim=axes))(Kp[:, None, :], axes=(-2, -1))
        Uf = (lambda x, axes=(-2, -1): torch.fft.rfft2(x.float(), dim=axes))(up[:, :, None, :], axes=(-2, -1))
        Yf = Uf * Kf[None, :, :, :]
        y = (lambda x, s, axes=(-2, -1): torch.fft.irfft2(x, s=s, dim=axes).to(torch.bfloat16))(Yf, (1, L2), axes=(-2, -1))[:, :, 0, :L]
        y = (lambda x, *d: x.permute(*d))(y, 0, 2, 1) + u * Dskip[None, None, :]
        return y

    def _B_ref(x, w_gate, w_up, w_down):
        g = torch.einsum('bsd,df->bsf', x, w_gate)
        u = torch.einsum('bsd,df->bsf', x, w_up)
        h = g * u
        return torch.einsum('bsf,fd->bsd', h, w_down)
    x = A_u
    mod = (_silu(c) @ w_mod).reshape(c.shape[0], 6, 1, -1)
    sa, ca, ga, sb, cb, gb = (mod[:, 0].clone(), mod[:, 1].clone(), mod[:, 2].clone(), mod[:, 3].clone(), mod[:, 4].clone(), mod[:, 5].clone())
    h = _layernorm(x, axis=-1) * (1 + ca) + sa
    x = x + ga * _A_ref(h, A_A_re, A_A_im, A_B_re, A_B_im, A_C_re, A_C_im, A_log_dt, A_Dskip)
    h = _layernorm(x, axis=-1) * (1 + cb) + sb
    x = x + gb * _B_ref(h, B_w_gate, B_w_up, B_w_down)
    return x
```

```asm
; @launch grid=(256,1,1) block=(256,1,1) lds=163840
.amdgcn_target "amdgcn-amd-amdhsa--gfx950"
.text
.p2align 12
.globl adaLN_cond__ssm_conv_s4__glu_gated_bilinear__prompt_kernel
.p2align 8
.type adaLN_cond__ssm_conv_s4__glu_gated_bilinear__prompt_kernel,@function
adaLN_cond__ssm_conv_s4__glu_gated_bilinear__prompt_kernel:
L_body:
    s_load_dwordx2 s[8:9], s[0:1], 0
    s_load_dwordx16 s[48:63], s[0:1], 8
    s_load_dwordx4 s[12:15], s[0:1], 104
    s_getpc_b64 s[36:37]
    s_bfe_u32 s25, s2, 0x50003
    s_lshl_b32 s38, s25, 4
    v_lshrrev_b32 v254, 4, v0
    v_add_lshl_u32 v254, v254, s38, 6
    global_load_dword v255, v254, s[36:37]
    s_cmp_ge_u32 s2, 256
    s_cbranch_scc1 L_end
    s_lshl_b32 s21, s2, 13
    v_lshlrev_b32 v5, 4, v0
    s_add_u32 s20, s21, 2048
    v_add_u32 v16, s20, v5
    s_and_b32 s26, s2, 7
    s_lshl_b32 s23, s26, 5
    s_add_u32 s23, s23, s25
    s_lshl_b32 s20, s23, 8
    v_add_lshl_u32 v17, s20, v0, 1
    s_waitcnt lgkmcnt(0)
    global_load_dwordx4 v[64:67], v16, s[8:9] offset:-2048
    global_load_dwordx4 v[68:71], v16, s[8:9] offset:2048
    s_load_dwordx2 s[4:5], s[0:1], 136
    s_load_dwordx2 s[40:41], s[0:1], 96
    v_lshrrev_b32 v2, 6, v0
    v_and_b32 v1, 63, v0
    v_readfirstlane_b32 s22, v2
    s_min_u32 s27, s25, 23
    s_mul_i32 s28, s27, 43
    s_lshr_b32 s28, s28, 8
    s_mul_i32 s20, s28, 6
    s_sub_u32 s20, s27, s20
    s_add_u32 s27, s27, s26
    s_and_b32 s27, s27, 7
    s_lshl3_add_u32 s27, s20, s27
    s_lshl2_add_u32 s20, s28, s22
    s_lshl_b32 s20, s20, 5
    v_and_b32 v18, 31, v1
    v_add_lshl_u32 v18, s20, v18, 1
    global_load_ushort v72, v18, s[12:13]
    v_lshrrev_b32 v19, 3, v1
    v_add_u32 v19, s20, v19
    v_mul_u32_u24 v19, 6144, v19
    v_lshlrev_b32 v6, 4, v1
    v_and_b32 v20, 0x70, v6
    s_lshl_b32 s20, s27, 7
    v_add3_u32 v19, v19, v20, s20
    s_lshl_b32 s24, s22, 12
    s_add_u32 m0, s24, 107520
    v_mov_b32 v242, 5242880
    s_cmp_ge_u32 s2, 192
    s_cbranch_scc1 L_nomod
    global_load_ushort v8, v17, s[48:49]
    global_load_ushort v9, v17, s[50:51]
    global_load_ushort v10, v17, s[52:53]
    global_load_ushort v11, v17, s[54:55]
    global_load_ushort v12, v17, s[56:57]
    global_load_ushort v13, v17, s[58:59]
    global_load_lds_dwordx4 v19, s[14:15]
    v_add_u32 v19, 48128, v19
    global_load_lds_dwordx4 v19, s[14:15] offset:1024
    v_add_u32 v19, 48128, v19
    global_load_lds_dwordx4 v19, s[14:15] offset:2048
    v_add_u32 v19, 48128, v19
    global_load_lds_dwordx4 v19, s[14:15] offset:3072
    s_branch L_modl
L_nomod:
    s_cmp_lg_u32 s2, 255
    s_waitcnt lgkmcnt(0)
    s_cbranch_scc1 L_noinit
    v_min_u32 v21, 35, v1
    v_lshl_add_u32 v21, v21, 2, v2
    v_lshlrev_b32 v21, 7, v21
    v_add_u32 v21, 4259840, v21
    v_mov_b32 v22, 0
    global_store_dword v21, v22, s[4:5] sc1
L_noinit:
    global_load_ushort v8, v17, s[48:49]
    global_load_ushort v9, v17, s[50:51]
    global_load_ushort v10, v17, s[52:53]
    global_load_ushort v11, v17, s[54:55]
    global_load_ushort v12, v17, s[56:57]
    global_load_ushort v13, v17, s[58:59]
    s_sub_u32 s20, 3, s26
    s_and_b32 s20, s20, 7
    s_min_u32 s29, s22, 2
    s_lshl3_add_u32 s20, s29, s20
    s_mul_i32 s29, s20, 43
    s_lshr_b32 s29, s29, 8
    s_mul_i32 s38, s29, 780288
    s_lshl_b32 s20, s20, 10
    s_add_u32 s20, s20, s38
    s_bfe_u32 s29, s2, 0x20004
    s_mul_i32 s29, s29, 196608
    s_add_u32 s20, s20, s29
    s_and_b32 s29, s2, 8
    v_and_b32 v16, 7, v1
    v_add3_u32 v16, v16, s29, 16
    v_mul_u32_u24 v16, 6144, v16
    v_add_u32 v16, s20, v16
    global_load_dword v255, v16, s[14:15] offset:384
    s_sub_u32 s20, s2, 192
    s_mul_i32 s20, s20, 28
    v_lshrrev_b32 v16, 3, v0
    v_min_u32 v16, 27, v16
    v_add_u32 v16, s20, v16
    v_and_b32 v18, 0x70, v6
    v_lshl_add_u32 v17, v16, 8, v18
    v_lshl_add_u32 v16, v16, 10, v18
    global_load_dwordx4 a[144:147], v16, s[40:41] offset:384
    v_add_u32 v242, v242, v17
L_modl:
    s_lshl_b32 s20, s23, 2
    s_load_dword s30, s[60:61], s20
    s_load_dword s31, s[62:63], s20
    s_load_dwordx2 s[10:11], s[0:1], 128
    s_load_dwordx4 s[16:19], s[0:1], 80
    s_load_dwordx2 s[6:7], s[0:1], 120
    s_or_b32 s39, s24, s2
    v_mov_b32 v52, 0
    v_mov_b32 v53, 0
    v_mov_b32 v54, 0
    v_mov_b32 v55, 0
    v_min_u32 v20, 464, v5
    ds_write_b128 v20, v[52:55] offset:58368
    ds_write_b128 v20, v[52:55] offset:62976
    v_and_b32 v14, 15, v1
    v_lshrrev_b32 v15, 4, v1
    s_lshr_b32 s32, s22, 1
    s_and_b32 s33, s22, 1
    v_mov_b32 v20, 84604
    ds_write2st64_b32 v20, v52, v52 offset0:0 offset1:11
    s_movk_i32 s36, -3488
    s_movk_i32 s37, 20640
    s_mul_i32 s45, s22, 14592
    s_mul_i32 s46, s32, 29184
    s_mul_i32 s47, s32, 4608
    s_min_u32 s20, s25, 27
    s_mul_i32 s34, s20, 37
    s_lshr_b32 s34, s34, 8
    s_mul_i32 s35, s34, 7
    s_sub_u32 s35, s20, s35
    s_and_b32 s20, s26, 1
    s_lshl_b32 s20, s20, 2
    s_add_u32 s34, s34, s20
    s_lshr_b32 s20, s26, 1
    s_mul_i32 s20, s20, 7
    s_add_u32 s35, s35, s20
    s_mul_i32 s20, s34, 229376
    s_lshl_b32 s29, s35, 7
    s_add_u32 s20, s20, s29
    v_lshrrev_b32 v20, 3, v0
    v_and_b32 v21, 7, v0
    v_mul_u32_u24 v7, 3584, v20
    v_lshl_add_u32 v7, v21, 4, v7
    v_add_u32 v7, s20, v7
    v_mul_u32_u24 v253, 2056, v21
    v_lshl_add_u32 v253, v20, 5, v253
    v_add_u32 v253, 67584, v253
    v_mul_u32_u24 v73, 1088, v2
    v_add_u32 v73, v73, v6
    v_add_u32 v73, 90112, v73
    v_bfe_u32 v74, v1, 2, 2
    v_mul_u32_u24 v74, 1088, v74
    v_lshrrev_b32 v20, 4, v0
    v_lshl_add_u32 v74, v20, 5, v74
    v_and_b32 v20, 3, v1
    v_lshl_add_u32 v74, v20, 3, v74
    v_add_u32 v74, 90112, v74
    s_lshl_b32 s20, s26, 7
    v_xor_b32 v75, s20, v5
    v_add_u32 v75, s21, v75
    v_add_u32 v76, 2101248, v75
    v_add_u32 v75, 4096, v75
    v_lshrrev_b32 v240, 2, v1
    v_lshlrev_b32 v240, 7, v240
    v_lshl_add_u32 v240, v20, 3, v240
    s_lshl_b32 s20, s22, 5
    s_add_u32 s20, s20, 90112
    v_add_u32 v240, s20, v240
    v_lshlrev_b32 v241, 3, v15
    v_add_u32 v241, 90112, v241
    s_mul_i32 s20, s28, 12288
    s_lshl_b32 s29, s27, 8
    s_add_u32 s20, s20, s29
    s_lshl_b32 s29, s22, 6
    s_add_u32 s20, s20, s29
    s_add_u32 s20, s20, 4194304
    v_lshl_add_u32 v243, v14, 2, s20
    s_add_u32 s20, s29, 90112
    v_and_b32 v79, 31, v1
    v_lshl_add_u32 v79, v79, 1, s20
    v_lshlrev_b32 v20, 3, v0
    v_sub_u32 v21, 2047, v20
    v_cvt_f32_u32 v24, v21
    v_subrev_f32 v25, 0x3f800000, v24
    v_subrev_f32 v26, 0x40000000, v24
    v_subrev_f32 v27, 0x40400000, v24
    v_subrev_f32 v28, 0x40800000, v24
    v_subrev_f32 v29, 0x40a00000, v24
    v_subrev_f32 v30, 0x40c00000, v24
    v_subrev_f32 v31, 0x40e00000, v24
    v_subrev_f32 v32, 0x41000000, v24
    v_max_f32 v32, 0, v32
    v_cvt_pk_bf16_f32 v34, v24, v25
    v_cvt_pk_bf16_f32 v35, v26, v27
    v_cvt_pk_bf16_f32 v36, v28, v29
    v_cvt_pk_bf16_f32 v37, v30, v31
    v_cvt_pk_bf16_f32 v38, v32, v32
    v_sub_u32 v24, 22559, v20
    v_sub_u32 v25, 22558, v20
    v_sub_u32 v26, 22557, v20
    v_sub_u32 v27, 22556, v20
    v_sub_u32 v28, 22555, v20
    v_sub_u32 v29, 22554, v20
    v_sub_u32 v30, 22553, v20
    v_sub_u32 v31, 22552, v20
    v_sub_u32 v32, 22551, v20
    v_subrev_u32_sdwa v22, s36, v34 dst_sel:DWORD dst_unused:UNUSED_PAD src0_sel:DWORD src1_sel:WORD_0
    s_nop 0
    v_med3_i32 v229, v24, s37, v22
    v_lshrrev_b32 v22, 5, v229
    v_add_lshl_u32 v229, v229, v22, 2
    v_subrev_u32_sdwa v23, s36, v34 dst_sel:DWORD dst_unused:UNUSED_PAD src0_sel:DWORD src1_sel:WORD_1
    s_nop 0
    v_med3_i32 v230, v25, s37, v23
    v_lshrrev_b32 v23, 5, v230
    v_add_lshl_u32 v230, v230, v23, 2
    v_subrev_u32_sdwa v22, s36, v35 dst_sel:DWORD dst_unused:UNUSED_PAD src0_sel:DWORD src1_sel:WORD_0
    s_nop 0
    v_med3_i32 v231, v26, s37, v22
    v_lshrrev_b32 v22, 5, v231
    v_add_lshl_u32 v231, v231, v22, 2
    v_subrev_u32_sdwa v23, s36, v35 dst_sel:DWORD dst_unused:UNUSED_PAD src0_sel:DWORD src1_sel:WORD_1
    s_nop 0
    v_med3_i32 v232, v27, s37, v23
    v_lshrrev_b32 v23, 5, v232
    v_add_lshl_u32 v232, v232, v23, 2
    v_subrev_u32_sdwa v22, s36, v36 dst_sel:DWORD dst_unused:UNUSED_PAD src0_sel:DWORD src1_sel:WORD_0
    s_nop 0
    v_med3_i32 v233, v28, s37, v22
    v_lshrrev_b32 v22, 5, v233
    v_add_lshl_u32 v233, v233, v22, 2
    v_subrev_u32_sdwa v23, s36, v36 dst_sel:DWORD dst_unused:UNUSED_PAD src0_sel:DWORD src1_sel:WORD_1
    s_nop 0
    v_med3_i32 v234, v29, s37, v23
    v_lshrrev_b32 v23, 5, v234
    v_add_lshl_u32 v234, v234, v23, 2
    v_subrev_u32_sdwa v22, s36, v37 dst_sel:DWORD dst_unused:UNUSED_PAD src0_sel:DWORD src1_sel:WORD_0
    s_nop 0
    v_med3_i32 v235, v30, s37, v22
    v_lshrrev_b32 v22, 5, v235
    v_add_lshl_u32 v235, v235, v22, 2
    v_subrev_u32_sdwa v23, s36, v37 dst_sel:DWORD dst_unused:UNUSED_PAD src0_sel:DWORD src1_sel:WORD_1
    s_nop 0
    v_med3_i32 v236, v31, s37, v23
    v_lshrrev_b32 v23, 5, v236
    v_add_lshl_u32 v236, v236, v23, 2
    v_subrev_u32_sdwa v22, s36, v38 dst_sel:DWORD dst_unused:UNUSED_PAD src0_sel:DWORD src1_sel:WORD_0
    s_nop 0
    v_med3_i32 v237, v32, s37, v22
    v_lshrrev_b32 v22, 5, v237
    v_add_lshl_u32 v237, v237, v22, 2
    v_mul_u32_u24 v247, 224, v1
    v_add_u32 v247, s45, v247
    v_lshrrev_b32 v20, 2, v1
    v_mul_u32_u24 v20, 224, v20
    v_and_b32 v21, 3, v1
    v_lshl_add_u32 v20, v21, 3, v20
    v_add_u32 v248, s46, v20
    s_lshl_b32 s20, s33, 5
    v_add_u32 v250, s20, v248
    s_lshl_b32 s20, s33, 7
    v_lshl_add_u32 v21, v14, 3, s20
    v_lshl_add_u32 v32, v15, 8, v21
    v_lshlrev_b32 v33, 1, v15
    v_mov_b32 v34, 0x104
    v_max_u32 v33, 2, v33
    v_cmp_eq_u32 vcc, 1, v15
    s_nop 1
    v_cndmask_b32 v33, v33, v34, vcc
    v_add_u32 v33, v33, v21
    v_lshl_add_u32 v34, v15, 10, v21
    v_add_u32 v34, 0x400, v34
    v_cvt_f32_u32 v35, v32
    v_cvt_f32_u32 v36, v33
    v_cvt_f32_u32 v37, v34
    v_cvt_pk_bf16_f32 v35, v35, v36
    v_cvt_pk_bf16_f32 v37, v37, v37
    v_add_u32 v32, 20512, v32
    v_add_u32 v33, 20512, v33
    v_add_u32 v34, 20512, v34
    v_subrev_u32_sdwa v22, s36, v35 dst_sel:DWORD dst_unused:UNUSED_PAD src0_sel:DWORD src1_sel:WORD_0
    s_nop 0
    v_med3_i32 v244, v32, s37, v22
    v_lshrrev_b32 v22, 5, v244
    v_add_lshl_u32 v244, v244, v22, 2
    v_subrev_u32_sdwa v23, s36, v35 dst_sel:DWORD dst_unused:UNUSED_PAD src0_sel:DWORD src1_sel:WORD_1
    s_nop 0
    v_med3_i32 v245, v33, s37, v23
    v_lshrrev_b32 v23, 5, v245
    v_add_lshl_u32 v245, v245, v23, 2
    v_subrev_u32_sdwa v22, s36, v37 dst_sel:DWORD dst_unused:UNUSED_PAD src0_sel:DWORD src1_sel:WORD_0
    s_nop 0
    v_med3_i32 v246, v34, s37, v22
    v_lshrrev_b32 v22, 5, v246
    v_add_lshl_u32 v246, v246, v22, 2
    s_mul_i32 s20, s32, 2816
    v_add_u32 v244, s20, v244
    v_add_u32 v245, s20, v245
    v_add_u32 v246, s20, v246
    v_and_b32 v239, 1, v1
    v_lshl_add_u32 v239, v239, 4, s45
    s_lshl_b32 s20, s33, 6
    v_add_u32 v239, s20, v239
    s_cmp_ge_u32 s2, 192
    s_cbranch_scc1 L_w0
    s_waitcnt vmcnt(10)
    s_branch L_w1
L_w0:
    s_waitcnt vmcnt(9)
    s_cmp_eq_u32 s2, 255
    s_cbranch_scc1 L_w1
    s_waitcnt vmcnt(8)
L_w1:
    ds_write_b128 v73, v[64:67] offset:0
    ds_write_b128 v73, v[68:71] offset:4352
    v_lshlrev_b32 v72, 16, v72
    v_mul_f32 v25, 0xbfb8aa3b, v72
    v_exp_f32 v25, v25
    v_lshlrev_b32 v32, 16, v64
    v_and_b32 v33, 0xffff0000, v64
    v_lshlrev_b32 v34, 16, v65
    v_and_b32 v35, 0xffff0000, v65
    v_lshlrev_b32 v36, 16, v66
    v_and_b32 v37, 0xffff0000, v66
    v_lshlrev_b32 v38, 16, v67
    v_and_b32 v39, 0xffff0000, v67
    v_add_f32 v25, 1.0, v25
    v_rcp_f32 v25, v25
    v_lshlrev_b32 v40, 16, v68
    v_and_b32 v41, 0xffff0000, v68
    v_lshlrev_b32 v42, 16, v69
    v_and_b32 v43, 0xffff0000, v69
    v_lshlrev_b32 v44, 16, v70
    v_and_b32 v45, 0xffff0000, v70
    v_lshlrev_b32 v46, 16, v71
    v_and_b32 v47, 0xffff0000, v71
    v_mul_f32 v25, v72, v25
    v_cvt_pk_bf16_f32 v25, v25, v25
    ds_write_b16 v79, v25 offset:33792
    v_pk_mul_f32 v[18:19], v[32:33], v[32:33]
    v_pk_mul_f32 v[22:23], v[40:41], v[40:41]
    v_pk_fma_f32 v[18:19], v[34:35], v[34:35], v[18:19]
    v_pk_add_f32 v[16:17], v[34:35], v[32:33]
    v_pk_fma_f32 v[22:23], v[42:43], v[42:43], v[22:23]
    v_pk_add_f32 v[20:21], v[42:43], v[40:41]
    v_pk_fma_f32 v[18:19], v[36:37], v[36:37], v[18:19]
    v_pk_add_f32 v[16:17], v[36:37], v[16:17]
    v_pk_fma_f32 v[22:23], v[44:45], v[44:45], v[22:23]
    v_pk_add_f32 v[20:21], v[44:45], v[20:21]
    v_pk_fma_f32 v[18:19], v[38:39], v[38:39], v[18:19]
    v_pk_add_f32 v[16:17], v[38:39], v[16:17]
    v_pk_fma_f32 v[22:23], v[46:47], v[46:47], v[22:23]
    v_pk_add_f32 v[20:21], v[46:47], v[20:21]
    v_add_f32 v16, v16, v17
    v_add_f32 v18, v18, v19
    v_add_f32 v20, v20, v21
    v_add_f32 v22, v22, v23
    v_add_f32_dpp v16, v16, v16 row_ror:8 row_mask:0xf bank_mask:0xf
    v_add_f32_dpp v18, v18, v18 row_ror:8 row_mask:0xf bank_mask:0xf
    v_add_f32_dpp v20, v20, v20 row_ror:8 row_mask:0xf bank_mask:0xf
    v_add_f32_dpp v22, v22, v22 row_ror:8 row_mask:0xf bank_mask:0xf
    v_add_f32_dpp v16, v16, v16 row_ror:4 row_mask:0xf bank_mask:0xf
    v_add_f32_dpp v18, v18, v18 row_ror:4 row_mask:0xf bank_mask:0xf
    v_add_f32_dpp v20, v20, v20 row_ror:4 row_mask:0xf bank_mask:0xf
    v_add_f32_dpp v22, v22, v22 row_ror:4 row_mask:0xf bank_mask:0xf
    v_add_f32_dpp v16, v16, v16 row_ror:2 row_mask:0xf bank_mask:0xf
    v_add_f32_dpp v18, v18, v18 row_ror:2 row_mask:0xf bank_mask:0xf
    v_add_f32_dpp v20, v20, v20 row_ror:2 row_mask:0xf bank_mask:0xf
    v_add_f32_dpp v22, v22, v22 row_ror:2 row_mask:0xf bank_mask:0xf
    v_add_f32_dpp v16, v16, v16 row_ror:1 row_mask:0xf bank_mask:0xf
    v_add_f32_dpp v18, v18, v18 row_ror:1 row_mask:0xf bank_mask:0xf
    v_add_f32_dpp v20, v20, v20 row_ror:1 row_mask:0xf bank_mask:0xf
    v_add_f32_dpp v22, v22, v22 row_ror:1 row_mask:0xf bank_mask:0xf
    v_mov_b32 v17, v16
    v_mov_b32 v19, v18
    v_mov_b32 v21, v20
    v_mov_b32 v23, v22
    v_permlane16_swap_b32 v16, v17
    v_permlane16_swap_b32 v18, v19
    v_permlane16_swap_b32 v20, v21
    v_permlane16_swap_b32 v22, v23
    v_add_f32 v16, v16, v17
    v_add_f32 v18, v18, v19
    v_add_f32 v20, v20, v21
    v_add_f32 v22, v22, v23
    v_mov_b32 v17, v16
    v_mov_b32 v19, v18
    v_mov_b32 v21, v20
    v_mov_b32 v23, v22
    v_permlane32_swap_b32 v16, v17
    v_permlane32_swap_b32 v18, v19
    v_permlane32_swap_b32 v20, v21
    v_permlane32_swap_b32 v22, v23
    v_add_f32 v16, v16, v17
    v_add_f32 v18, v18, v19
    v_add_f32 v20, v20, v21
    v_add_f32 v22, v22, v23
    v_mul_f32 v16, 0xbb000000, v16
    v_mul_f32 v20, 0xbb000000, v20
    v_mul_f32 v18, 0x3b000000, v18
    v_mul_f32 v22, 0x3b000000, v22
    v_fma_f32 v18, -v16, v16, v18
    v_fma_f32 v22, -v20, v20, v22
    v_max_f32 v18, 0, v18
    v_max_f32 v22, 0, v22
    v_add_f32 v18, 0x3727c5ac, v18
    v_add_f32 v22, 0x3727c5ac, v22
    v_rsq_f32 v18, v18
    v_rsq_f32 v22, v22
    v_mul_f32 v16, v16, v18
    v_mul_f32 v20, v20, v22
    v_pk_fma_f32 v[32:33], v[32:33], v[18:19], v[16:17] op_sel_hi:[1,0,0]
    v_pk_fma_f32 v[34:35], v[34:35], v[18:19], v[16:17] op_sel_hi:[1,0,0]
    v_pk_fma_f32 v[36:37], v[36:37], v[18:19], v[16:17] op_sel_hi:[1,0,0]
    v_pk_fma_f32 v[38:39], v[38:39], v[18:19], v[16:17] op_sel_hi:[1,0,0]
    v_pk_fma_f32 v[40:41], v[40:41], v[22:23], v[20:21] op_sel_hi:[1,0,0]
    v_pk_fma_f32 v[42:43], v[42:43], v[22:23], v[20:21] op_sel_hi:[1,0,0]
    v_pk_fma_f32 v[44:45], v[44:45], v[22:23], v[20:21] op_sel_hi:[1,0,0]
    v_pk_fma_f32 v[46:47], v[46:47], v[22:23], v[20:21] op_sel_hi:[1,0,0]
    v_cvt_pk_bf16_f32 v64, v32, v33
    v_cvt_pk_bf16_f32 v65, v34, v35
    v_cvt_pk_bf16_f32 v66, v36, v37
    v_cvt_pk_bf16_f32 v67, v38, v39
    v_cvt_pk_bf16_f32 v68, v40, v41
    v_cvt_pk_bf16_f32 v69, v42, v43
    v_cvt_pk_bf16_f32 v70, v44, v45
    v_cvt_pk_bf16_f32 v71, v46, v47
    ds_write_b128 v73, v[64:67] offset:8704
    ds_write_b128 v73, v[68:71] offset:13056
    s_cmp_lg_u32 s2, 255
    s_cbranch_scc1 L_nowait
    s_waitcnt vmcnt(8)
L_nowait:
    s_cmp_lg_u32 s39, 255
    s_waitcnt lgkmcnt(0)
    s_barrier
    s_cbranch_scc1 L_noflag
    v_mov_b32 v16, 1
    global_store_dword v52, v16, s[10:11] sc1
L_noflag:
    ds_read_b64_tr_b16 v[80:81], v74 offset:8704
    ds_read_b64_tr_b16 v[82:83], v74 offset:13056
    ds_read_b64_tr_b16 v[84:85], v74 offset:9216
    ds_read_b64_tr_b16 v[86:87], v74 offset:13568
    ds_read_b64_tr_b16 v[88:89], v74 offset:0
    ds_read_b64_tr_b16 v[90:91], v74 offset:4352
    ds_read_b64_tr_b16 v[92:93], v74 offset:512
    ds_read_b64_tr_b16 v[94:95], v74 offset:4864
    s_waitcnt lgkmcnt(6)
    global_store_dwordx4 v76, v[80:83], s[4:5] offset:-4096 sc1
    v_sub_u32 v56, 15, v14
    v_lshrrev_b32 v57, 1, v56
    v_lshl_add_u32 v57, v15, 2, v57
    v_lshlrev_b32 v57, 2, v57
    v_and_b32 v56, 1, v56
    v_mul_u32_u24 v56, 14656, v56
    s_lshl_b32 s29, s33, 8
    s_add_u32 s20, s46, s29
    s_add_u32 s20, s20, 4096
    v_add3_u32 v60, v56, v57, s20
    v_add_u32 v61, 1024, v60
    v_add_u32 v62, 2048, v60
    s_waitcnt lgkmcnt(4)
    global_store_dwordx4 v76, v[84:87], s[4:5] offset:0 sc1
    v_add_u32 v63, 3072, v60
    s_add_u32 s20, s47, s29
    v_lshlrev_b32 v58, 5, v14
    v_lshl_add_u32 v58, v15, 4, v58
    v_add_u32 v58, s20, v58
    v_lshlrev_b32 v59, 6, v14
    v_and_b32 v21, 2, v15
    v_lshl_add_u32 v59, v21, 4, v59
    v_and_b32 v21, 1, v15
    v_lshl_add_u32 v59, v21, 3, v59
    s_mul_i32 s20, s33, 14592
    s_lshl_b32 s38, s32, 4
    s_waitcnt lgkmcnt(2)
    global_store_dwordx4 v75, v[88:91], s[4:5] offset:-4096 sc1
    s_add_u32 s20, s20, s38
    v_add_u32 v59, s20, v59
    v_lshrrev_b32 v20, 1, v0
    v_and_b32 v21, 1, v0
    v_lshlrev_b32 v238, 13, v20
    v_lshl_add_u32 v238, v21, 4, v238
    s_lshl_b32 s20, s23, 5
    v_and_b32 v22, 7, v20
    v_lshlrev_b32 v22, 7, v22
    v_xor_b32 v22, s20, v22
    v_add_u32 v238, v22, v238
    v_add_u32 v249, 0x100000, v238
    s_waitcnt lgkmcnt(0)
    global_store_dwordx4 v75, v[92:95], s[4:5] offset:0 sc1
    v_add_u32 v251, 2097152, v238
    v_add_u32 v252, 2097152, v249
    v_mul_u32_u24 v3, 4608, v21
    v_lshl_add_u32 v3, v20, 4, v3
    v_and_b32 v56, 3, v20
    v_mul_u32_u24 v56, 12288, v56
    v_lshl_add_u32 v56, v21, 2, v56
    s_lshl_b32 s20, s23, 3
    s_add_u32 s20, s20, 4196352
    v_add_u32 v56, s20, v56
    s_lshl_b32 s20, s32, 4
    s_lshr_b32 s30, s30, s20
    s_lshl_b32 s30, s30, 16
    v_mov_b32 v20, 0x3fb8aa3b
    v_mul_f32 v20, s30, v20
    v_exp_f32 v20, v20
    s_lshr_b32 s31, s31, s20
    s_lshl_b32 s31, s31, 16
    v_cvt_pk_bf16_f32 v20, v20, v20
    v_lshlrev_b32 v20, 16, v20
    v_mul_f32 v21, 0x3fb8aa3b, v20
    v_mul_f32 v22, 0x3e22f983, v20
    s_waitcnt vmcnt(8)
    s_cmp_lt_u32 s2, 192
    s_cbranch_scc1 L_prm
    s_waitcnt vmcnt(6)
L_prm:
    v_lshlrev_b32 v25, 16, v9
    v_lshlrev_b32 v24, 16, v8
    v_lshlrev_b32 v26, 16, v10
    v_mul_f32 v31, v25, v22
    v_lshlrev_b32 v27, 16, v11
    v_mul_f32 v30, v24, v21
    v_rndne_f32 v34, v31
    v_lshlrev_b32 v28, 16, v12
    v_lshlrev_b32 v29, 16, v13
    v_sub_f32 v35, v31, v34
    s_waitcnt vmcnt(4) lgkmcnt(0)
    s_barrier
    ds_read_b64_tr_b16 a[0:1], v240 offset:17408
    ds_read_b64 a[16:17], v241 offset:33792
    ds_read_b64_tr_b16 a[2:3], v240 offset:19456
    ds_read_b64 a[18:19], v241 offset:33824
    ds_read_b64_tr_b16 a[4:5], v240 offset:21504
    ds_read_b64 a[20:21], v241 offset:33856
    ds_read_b64_tr_b16 a[6:7], v240 offset:23552
    ds_read_b64 a[22:23], v241 offset:33888
    ds_read_b64_tr_b16 a[8:9], v240 offset:25600
    ds_read_b64 a[24:25], v241 offset:33920
    ds_read_b64_tr_b16 a[10:11], v240 offset:27648
    ds_read_b64 a[26:27], v241 offset:33952
    ds_read_b64_tr_b16 a[12:13], v240 offset:29696
    ds_read_b64 a[28:29], v241 offset:33984
    ds_read_b64_tr_b16 a[14:15], v240 offset:31744
    ds_read_b64 a[30:31], v241 offset:34016
    v_mul_f32 v32, v26, v20
    v_mul_f32 v33, v27, v20
    v_mul_f32 v40, 0x41000000, v30
    v_mul_f32 v41, 0x41000000, v35
    v_pk_mul_f32 v[76:77], v[28:29], v[32:33] op_sel:[1,0] op_sel_hi:[1,1] neg_hi:[1,0]
    v_exp_f32 v40, v40
    v_cos_f32 v42, v41
    v_sin_f32 v43, v41
    s_waitcnt lgkmcnt(12)
    v_mfma_f32_16x16x32_bf16 a[32:35], a[16:19], a[0:3], 0
    s_waitcnt lgkmcnt(8)
    v_mfma_f32_16x16x32_bf16 a[32:35], a[20:23], a[4:7], a[32:35]
    s_waitcnt lgkmcnt(4)
    v_mfma_f32_16x16x32_bf16 a[32:35], a[24:27], a[8:11], a[32:35]
    s_waitcnt lgkmcnt(0)
    v_mfma_f32_16x16x32_bf16 a[32:35], a[28:31], a[12:15], a[32:35]
    v_pk_fma_f32 v[76:77], v[32:33], v[28:29], v[76:77] op_sel:[1,0,0] op_sel_hi:[0,0,1]
    v_exp_f32 v36, v30
    v_pk_mul_f32 v[66:67], v[42:43], v[40:41] op_sel_hi:[1,0]
    v_cos_f32 v38, v35
    v_sin_f32 v39, v35
    v_pk_mul_f32 v[72:73], v[66:67], v[66:67] op_sel:[1,0] op_sel_hi:[1,1] neg_hi:[1,0]
    v_pk_mul_f32 v[78:79], v[76:77], v[66:67] op_sel:[1,0] op_sel_hi:[1,1]
    v_pk_mul_f32 v[64:65], v[38:39], v[36:37] op_sel_hi:[1,0]
    s_nop 0
    s_cmp_lt_u32 s2, 192
    s_cbranch_scc1 L_modst
    global_store_dwordx4 v242, a[144:147], s[4:5] sc1
    s_branch L_pub
L_modst:
    s_mov_b64 exec, 0xffff
    global_store_dword v243, a32, s[4:5] sc1
    s_mov_b64 exec, -1
L_pub:
    global_load_dword v23, v52, s[10:11] sc1
    v_pk_fma_f32 v[72:73], v[66:67], v[66:67], v[72:73] op_sel:[1,0,0] op_sel_hi:[0,0,1]
    v_pk_fma_f32 v[78:79], v[66:67], v[76:77], v[78:79] op_sel:[1,0,0] op_sel_hi:[0,0,1] neg_lo:[1,0,0]
    v_cvt_pk_bf16_f32 v208, 1.0, v64
    v_pk_mul_f32 v[74:75], v[72:73], v[72:73] op_sel:[1,0] op_sel_hi:[1,1]
    v_cvt_pk_bf16_f32 v176, v77, v78
    v_cvt_pk_bf16_f32 v180, -v76, -v79
    v_pk_mul_f32 v[80:81], v[76:77], v[72:73] op_sel:[1,0] op_sel_hi:[1,1]
    v_pk_mul_f32 v[82:83], v[78:79], v[72:73] op_sel:[1,0] op_sel_hi:[1,1] neg_lo:[1,0]
    v_mul_f32 v44, 0x42800000, v30
    v_mul_f32 v45, 0x42800000, v35
    v_mul_f32 v48, 0x43800000, v30
    v_mul_f32 v49, 0x43800000, v35
    v_pk_fma_f32 v[74:75], v[72:73], v[72:73], v[74:75] op_sel:[1,0,0] op_sel_hi:[0,0,1] neg_hi:[1,0,0]
    v_pk_fma_f32 v[80:81], v[72:73], v[76:77], v[80:81] op_sel:[1,0,0] op_sel_hi:[0,0,1] neg_hi:[1,0,0]
    v_pk_fma_f32 v[82:83], v[72:73], v[78:79], v[82:83] op_sel:[1,0,0] op_sel_hi:[0,0,1]
    v_exp_f32 v44, v44
    v_cos_f32 v46, v45
    v_cvt_pk_bf16_f32 v177, v81, v82
    v_cvt_pk_bf16_f32 v181, -v80, -v83
    v_sin_f32 v47, v45
    v_exp_f32 v48, v48
    v_cos_f32 v50, v49
    v_sin_f32 v51, v49
    v_pk_mul_f32 v[84:85], v[76:77], v[74:75] op_sel:[1,0] op_sel_hi:[1,1]
    v_pk_mul_f32 v[86:87], v[78:79], v[74:75] op_sel:[1,0] op_sel_hi:[1,1] neg_lo:[1,0]
    v_pk_mul_f32 v[88:89], v[80:81], v[74:75] op_sel:[1,0] op_sel_hi:[1,1]
    v_pk_mul_f32 v[90:91], v[82:83], v[74:75] op_sel:[1,0] op_sel_hi:[1,1] neg_lo:[1,0]
    v_pk_mul_f32 v[140:141], v[64:65], v[64:65] op_sel:[1,0] op_sel_hi:[1,1] neg_hi:[1,0]
    v_pk_mul_f32 v[68:69], v[46:47], v[44:45] op_sel_hi:[1,0]
    v_pk_mul_f32 v[70:71], v[50:51], v[48:49] op_sel_hi:[1,0]
    v_pk_fma_f32 v[84:85], v[74:75], v[76:77], v[84:85] op_sel:[1,0,0] op_sel_hi:[0,0,1] neg_hi:[1,0,0]
    v_pk_fma_f32 v[86:87], v[74:75], v[78:79], v[86:87] op_sel:[1,0,0] op_sel_hi:[0,0,1]
    v_pk_fma_f32 v[88:89], v[74:75], v[80:81], v[88:89] op_sel:[1,0,0] op_sel_hi:[0,0,1] neg_hi:[1,0,0]
    v_pk_fma_f32 v[90:91], v[74:75], v[82:83], v[90:91] op_sel:[1,0,0] op_sel_hi:[0,0,1]
    v_cvt_pk_bf16_f32 v178, v85, v86
    v_cvt_pk_bf16_f32 v182, -v84, -v87
    v_cvt_pk_bf16_f32 v179, v89, v90
    v_cvt_pk_bf16_f32 v183, -v88, -v91
    v_pk_fma_f32 v[140:141], v[64:65], v[64:65], v[140:141] op_sel:[1,0,0] op_sel_hi:[0,0,1]
    ds_write_b128 v247, v[176:179] offset:0
    v_pk_mul_f32 v[92:93], v[76:77], v[68:69] op_sel:[1,0] op_sel_hi:[1,1]
    ds_write_b128 v247, v[180:183] offset:112
    v_pk_mul_f32 v[94:95], v[78:79], v[68:69] op_sel:[1,0] op_sel_hi:[1,1] neg_hi:[1,0]
    v_pk_mul_f32 v[96:97], v[80:81], v[68:69] op_sel:[1,0] op_sel_hi:[1,1]
    v_pk_mul_f32 v[98:99], v[82:83], v[68:69] op_sel:[1,0] op_sel_hi:[1,1] neg_hi:[1,0]
    v_pk_mul_f32 v[100:101], v[84:85], v[68:69] op_sel:[1,0] op_sel_hi:[1,1]
    v_pk_mul_f32 v[102:103], v[86:87], v[68:69] op_sel:[1,0] op_sel_hi:[1,1] neg_hi:[1,0]
    v_pk_mul_f32 v[104:105], v[88:89], v[68:69] op_sel:[1,0] op_sel_hi:[1,1]
    v_pk_mul_f32 v[106:107], v[90:91], v[68:69] op_sel:[1,0] op_sel_hi:[1,1] neg_hi:[1,0]
    v_pk_mul_f32 v[144:145], v[140:141], v[140:141] op_sel:[1,0] op_sel_hi:[1,1]
    v_pk_mul_f32 v[158:159], v[70:71], v[70:71] op_sel:[1,0] op_sel_hi:[1,1] neg_hi:[1,0]
    v_pk_fma_f32 v[92:93], v[68:69], v[76:77], v[92:93] op_sel:[1,0,0] op_sel_hi:[0,0,1] neg_lo:[1,0,0]
    v_pk_fma_f32 v[94:95], v[68:69], v[78:79], v[94:95] op_sel:[1,0,0] op_sel_hi:[0,0,1]
    v_pk_fma_f32 v[96:97], v[68:69], v[80:81], v[96:97] op_sel:[1,0,0] op_sel_hi:[0,0,1] neg_lo:[1,0,0]
    v_pk_fma_f32 v[98:99], v[68:69], v[82:83], v[98:99] op_sel:[1,0,0] op_sel_hi:[0,0,1]
    v_cvt_pk_bf16_f32 v184, v92, v95
    v_cvt_pk_bf16_f32 v188, -v93, -v94
    v_cvt_pk_bf16_f32 v185, v96, v99
    v_cvt_pk_bf16_f32 v189, -v97, -v98
    v_pk_fma_f32 v[100:101], v[68:69], v[84:85], v[100:101] op_sel:[1,0,0] op_sel_hi:[0,0,1] neg_lo:[1,0,0]
    v_pk_fma_f32 v[102:103], v[68:69], v[86:87], v[102:103] op_sel:[1,0,0] op_sel_hi:[0,0,1]
    v_pk_fma_f32 v[104:105], v[68:69], v[88:89], v[104:105] op_sel:[1,0,0] op_sel_hi:[0,0,1] neg_lo:[1,0,0]
    v_pk_fma_f32 v[106:107], v[68:69], v[90:91], v[106:107] op_sel:[1,0,0] op_sel_hi:[0,0,1]
    v_cvt_pk_bf16_f32 v186, v100, v103
    v_cvt_pk_bf16_f32 v190, -v101, -v102
    v_cvt_pk_bf16_f32 v187, v104, v107
    v_cvt_pk_bf16_f32 v191, -v105, -v106
    v_pk_fma_f32 v[144:145], v[140:141], v[140:141], v[144:145] op_sel:[1,0,0] op_sel_hi:[0,0,1] neg_hi:[1,0,0]
    ds_write_b128 v247, v[184:187] offset:16
    v_pk_fma_f32 v[158:159], v[70:71], v[70:71], v[158:159] op_sel:[1,0,0] op_sel_hi:[0,0,1]
    ds_write_b128 v247, v[188:191] offset:128
    v_pk_mul_f32 v[108:109], v[92:93], v[68:69] op_sel:[1,0] op_sel_hi:[1,1] neg_hi:[1,0]
    v_pk_mul_f32 v[110:111], v[94:95], v[68:69] op_sel:[1,0] op_sel_hi:[1,1]
    v_pk_mul_f32 v[112:113], v[96:97], v[68:69] op_sel:[1,0] op_sel_hi:[1,1] neg_hi:[1,0]
    v_pk_mul_f32 v[114:115], v[98:99], v[68:69] op_sel:[1,0] op_sel_hi:[1,1]
    v_pk_mul_f32 v[116:117], v[100:101], v[68:69] op_sel:[1,0] op_sel_hi:[1,1] neg_hi:[1,0]
    v_pk_mul_f32 v[118:119], v[102:103], v[68:69] op_sel:[1,0] op_sel_hi:[1,1]
    v_pk_mul_f32 v[120:121], v[104:105], v[68:69] op_sel:[1,0] op_sel_hi:[1,1] neg_hi:[1,0]
    v_pk_mul_f32 v[122:123], v[106:107], v[68:69] op_sel:[1,0] op_sel_hi:[1,1]
    v_pk_mul_f32 v[142:143], v[140:141], v[64:65] op_sel:[1,0] op_sel_hi:[1,1]
    v_pk_mul_f32 v[148:149], v[144:145], v[140:141] op_sel:[1,0] op_sel_hi:[1,1]
    v_pk_mul_f32 v[162:163], v[158:159], v[70:71] op_sel:[1,0] op_sel_hi:[1,1]
    v_pk_mul_f32 v[166:167], v[158:159], v[158:159] op_sel:[1,0] op_sel_hi:[1,1]
    v_pk_fma_f32 v[108:109], v[68:69], v[92:93], v[108:109] op_sel:[1,0,0] op_sel_hi:[0,0,1]
    v_pk_fma_f32 v[110:111], v[68:69], v[94:95], v[110:111] op_sel:[1,0,0] op_sel_hi:[0,0,1] neg_lo:[1,0,0]
    v_pk_fma_f32 v[112:113], v[68:69], v[96:97], v[112:113] op_sel:[1,0,0] op_sel_hi:[0,0,1]
    v_pk_fma_f32 v[114:115], v[68:69], v[98:99], v[114:115] op_sel:[1,0,0] op_sel_hi:[0,0,1] neg_lo:[1,0,0]
    v_cvt_pk_bf16_f32 v192, v109, v110
    s_and_b32 s0, s2, 7
    s_lshl_b32 s0, s0, 7
    s_add_u32 s0, s0, 4276224
    v_mov_b32 v17, s0
    v_mov_b32 v18, 1
    s_waitcnt vmcnt(0)
    s_barrier
    s_cmp_lg_u32 s22, 0
    s_cbranch_scc1 L_arr1
    v_cmp_eq_u32 vcc, 1, v23
    s_cbranch_vccnz L_rdy_x
    s_mov_b32 s3, 0
L_rdy:
    global_load_dword v23, v52, s[10:11] sc1
    s_add_u32 s3, s3, 1
    s_cmp_gt_u32 s3, 400000
    s_cbranch_scc1 L_rdy_x
L_rdy_t:
    s_waitcnt vmcnt(0)
    v_cmp_ne_u32 vcc, 1, v23
    s_cbranch_vccnz L_rdy
L_rdy_x:
    s_mov_b64 exec, 1
    global_atomic_add v19, v17, v18, s[4:5] sc0 sc1
    s_mov_b64 exec, -1
L_arr1:
    s_mov_b64 s[8:9], s[40:41]
    v_cvt_pk_bf16_f32 v196, -v108, -v111
    v_cvt_pk_bf16_f32 v193, v113, v114
    v_cvt_pk_bf16_f32 v197, -v112, -v115
    v_pk_fma_f32 v[116:117], v[68:69], v[100:101], v[116:117] op_sel:[1,0,0] op_sel_hi:[0,0,1]
    v_pk_fma_f32 v[118:119], v[68:69], v[102:103], v[118:119] op_sel:[1,0,0] op_sel_hi:[0,0,1] neg_lo:[1,0,0]
    v_pk_fma_f32 v[120:121], v[68:69], v[104:105], v[120:121] op_sel:[1,0,0] op_sel_hi:[0,0,1]
    v_pk_fma_f32 v[122:123], v[68:69], v[106:107], v[122:123] op_sel:[1,0,0] op_sel_hi:[0,0,1] neg_lo:[1,0,0]
    v_cvt_pk_bf16_f32 v194, v117, v118
    v_cvt_pk_bf16_f32 v198, -v116, -v119
    v_cvt_pk_bf16_f32 v195, v121, v122
    v_add_u32 v254, 114688, v7
    v_cvt_pk_bf16_f32 v199, -v120, -v123
    v_pk_fma_f32 v[142:143], v[64:65], v[140:141], v[142:143] op_sel:[1,0,0] op_sel_hi:[0,0,1] neg_lo:[1,0,0]
    ds_write_b128 v247, v[192:195] offset:32
    v_pk_fma_f32 v[148:149], v[140:141], v[144:145], v[148:149] op_sel:[1,0,0] op_sel_hi:[0,0,1] neg_hi:[1,0,0]
    ds_write_b128 v247, v[196:199] offset:144
    v_cvt_pk_bf16_f32 v209, v141, v142
    v_cvt_pk_bf16_f32 v212, 0, v65
    v_pk_fma_f32 v[162:163], v[70:71], v[158:159], v[162:163] op_sel:[1,0,0] op_sel_hi:[0,0,1] neg_lo:[1,0,0]
    v_pk_fma_f32 v[166:167], v[158:159], v[158:159], v[166:167] op_sel:[1,0,0] op_sel_hi:[0,0,1] neg_hi:[1,0,0]
    v_pk_mul_f32 v[124:125], v[108:109], v[68:69] op_sel:[1,0] op_sel_hi:[1,1]
    v_pk_mul_f32 v[126:127], v[110:111], v[68:69] op_sel:[1,0] op_sel_hi:[1,1] neg_hi:[1,0]
    v_pk_mul_f32 v[128:129], v[112:113], v[68:69] op_sel:[1,0] op_sel_hi:[1,1]
    v_pk_mul_f32 v[130:131], v[114:115], v[68:69] op_sel:[1,0] op_sel_hi:[1,1] neg_hi:[1,0]
    v_pk_mul_f32 v[132:133], v[116:117], v[68:69] op_sel:[1,0] op_sel_hi:[1,1]
    v_pk_mul_f32 v[134:135], v[118:119], v[68:69] op_sel:[1,0] op_sel_hi:[1,1] neg_hi:[1,0]
    v_pk_mul_f32 v[136:137], v[120:121], v[68:69] op_sel:[1,0] op_sel_hi:[1,1]
    v_pk_mul_f32 v[138:139], v[122:123], v[68:69] op_sel:[1,0] op_sel_hi:[1,1] neg_hi:[1,0]
    global_load_dwordx4 a[128:131], v7, s[16:17]
    v_pk_mul_f32 v[146:147], v[144:145], v[64:65] op_sel:[1,0] op_sel_hi:[1,1]
    v_pk_mul_f32 v[150:151], v[144:145], v[142:143] op_sel:[1,0] op_sel_hi:[1,1]
    v_pk_mul_f32 v[152:153], v[70:71], v[140:141] op_sel:[1,0] op_sel_hi:[1,1] neg_lo:[1,0]
    v_pk_mul_f32 v[154:155], v[70:71], v[144:145] op_sel:[1,0] op_sel_hi:[1,1] neg_lo:[1,0]
    v_pk_mul_f32 v[156:157], v[70:71], v[148:149] op_sel:[1,0] op_sel_hi:[1,1] neg_lo:[1,0]
    v_pk_mul_f32 v[160:161], v[158:159], v[144:145] op_sel:[1,0] op_sel_hi:[1,1]
    v_pk_mul_f32 v[164:165], v[162:163], v[144:145] op_sel:[1,0] op_sel_hi:[1,1] neg_lo:[1,0]
    v_pk_mul_f32 v[168:169], v[166:167], v[70:71] op_sel:[1,0] op_sel_hi:[1,1]
    v_pk_mul_f32 v[170:171], v[166:167], v[158:159] op_sel:[1,0] op_sel_hi:[1,1]
    v_pk_mul_f32 v[172:173], v[166:167], v[162:163] op_sel:[1,0] op_sel_hi:[1,1]
    v_pk_mul_f32 v[174:175], v[166:167], v[166:167] op_sel:[1,0] op_sel_hi:[1,1]
    v_pk_fma_f32 v[124:125], v[68:69], v[108:109], v[124:125] op_sel:[1,0,0] op_sel_hi:[0,0,1] neg_lo:[1,0,0]
    v_pk_fma_f32 v[126:127], v[68:69], v[110:111], v[126:127] op_sel:[1,0,0] op_sel_hi:[0,0,1]
    v_pk_fma_f32 v[128:129], v[68:69], v[112:113], v[128:129] op_sel:[1,0,0] op_sel_hi:[0,0,1] neg_lo:[1,0,0]
    v_pk_fma_f32 v[130:131], v[68:69], v[114:115], v[130:131] op_sel:[1,0,0] op_sel_hi:[0,0,1]
    v_cvt_pk_bf16_f32 v200, v124, v127
    global_load_dwordx4 a[132:135], v7, s[18:19]
    v_cvt_pk_bf16_f32 v204, -v125, -v126
    v_cvt_pk_bf16_f32 v201, v128, v131
    v_cvt_pk_bf16_f32 v205, -v129, -v130
    v_pk_fma_f32 v[132:133], v[68:69], v[116:117], v[132:133] op_sel:[1,0,0] op_sel_hi:[0,0,1] neg_lo:[1,0,0]
    v_pk_fma_f32 v[134:135], v[68:69], v[118:119], v[134:135] op_sel:[1,0,0] op_sel_hi:[0,0,1]
    v_pk_fma_f32 v[136:137], v[68:69], v[120:121], v[136:137] op_sel:[1,0,0] op_sel_hi:[0,0,1] neg_lo:[1,0,0]
    v_pk_fma_f32 v[138:139], v[68:69], v[122:123], v[138:139] op_sel:[1,0,0] op_sel_hi:[0,0,1]
    v_cvt_pk_bf16_f32 v202, v132, v135
    v_cvt_pk_bf16_f32 v206, -v133, -v134
    v_cvt_pk_bf16_f32 v203, v136, v139
    v_cvt_pk_bf16_f32 v207, -v137, -v138
    v_pk_fma_f32 v[146:147], v[64:65], v[144:145], v[146:147] op_sel:[1,0,0] op_sel_hi:[0,0,1] neg_lo:[1,0,0]
    ds_write_b128 v247, v[200:203] offset:48
    v_pk_fma_f32 v[150:151], v[142:143], v[144:145], v[150:151] op_sel:[1,0,0] op_sel_hi:[0,0,1] neg_lo:[1,0,0]
    ds_write_b128 v247, v[204:207] offset:160
    v_cvt_pk_bf16_f32 v213, v140, v143
    v_cvt_pk_bf16_f32 v217, v145, v146
    global_load_dwordx4 a[136:139], v254, s[16:17]
    v_cvt_pk_bf16_f32 v219, v149, v150
    v_cvt_pk_bf16_f32 v221, v144, v147
    v_pk_fma_f32 v[152:153], v[140:141], v[70:71], v[152:153] op_sel:[1,0,0] op_sel_hi:[0,0,1]
    v_pk_fma_f32 v[154:155], v[144:145], v[70:71], v[154:155] op_sel:[1,0,0] op_sel_hi:[0,0,1]
    v_pk_fma_f32 v[156:157], v[148:149], v[70:71], v[156:157] op_sel:[1,0,0] op_sel_hi:[0,0,1]
    v_cvt_pk_bf16_f32 v210, v70, v152
    v_cvt_pk_bf16_f32 v214, v71, v153
    v_cvt_pk_bf16_f32 v211, v154, v156
    v_cvt_pk_bf16_f32 v215, v155, v157
    v_pk_fma_f32 v[160:161], v[144:145], v[158:159], v[160:161] op_sel:[1,0,0] op_sel_hi:[0,0,1] neg_hi:[1,0,0]
    ds_write_b128 v247, v[208:211] offset:64
    v_pk_fma_f32 v[164:165], v[144:145], v[162:163], v[164:165] op_sel:[1,0,0] op_sel_hi:[0,0,1]
    ds_write_b128 v247, v[212:215] offset:176
    v_cvt_pk_bf16_f32 v216, v159, v161
    v_cvt_pk_bf16_f32 v218, v162, v164
    v_cvt_pk_bf16_f32 v220, v158, v160
    global_load_dwordx4 a[140:143], v254, s[18:19]
    v_cvt_pk_bf16_f32 v222, v163, v165
    ds_write_b128 v247, v[216:219] offset:80
    v_pk_fma_f32 v[168:169], v[70:71], v[166:167], v[168:169] op_sel:[1,0,0] op_sel_hi:[0,0,1] neg_lo:[1,0,0]
    v_pk_fma_f32 v[170:171], v[158:159], v[166:167], v[170:171] op_sel:[1,0,0] op_sel_hi:[0,0,1] neg_hi:[1,0,0]
    v_pk_fma_f32 v[172:173], v[162:163], v[166:167], v[172:173] op_sel:[1,0,0] op_sel_hi:[0,0,1] neg_lo:[1,0,0]
    v_cvt_pk_bf16_f32 v223, v148, v151
    v_cvt_pk_bf16_f32 v224, v167, v168
    v_cvt_pk_bf16_f32 v225, v171, v172
    ds_write_b128 v247, v[220:223] offset:192
    v_cvt_pk_bf16_f32 v8, v166, v169
    v_pk_fma_f32 v[174:175], v[166:167], v[166:167], v[174:175] op_sel:[1,0,0] op_sel_hi:[0,0,1] neg_hi:[1,0,0]
    v_cvt_pk_bf16_f32 v9, v170, v173
    v_cvt_pk_bf16_f32 v226, v175, v175
    v_cvt_pk_bf16_f32 v10, v174, v174
    ds_write_b128 v247, v[224:227] offset:96
    ds_write_b128 v247, v[8:11] offset:208
    s_cmp_lg_u32 s22, 0
    s_cbranch_scc1 L_a1_done
    v_lshlrev_b32 v17, 7, v1
    v_add_u32 v17, 4259840, v17
    s_waitcnt vmcnt(4)
    v_readfirstlane_b32 s0, v19
    s_nop 0
    s_cmp_lg_u32 s0, 31
    s_cbranch_scc1 L_a1_done
    s_mov_b64 exec, -1
    global_atomic_add v17, v18, s[4:5] sc1
    s_mov_b64 exec, -1
L_a1_done:
    s_waitcnt lgkmcnt(0)
    s_barrier
    ds_read_b64_tr_b16 a[0:1], v250 offset:0
    ds_read_b64_tr_b16 a[2:3], v250 offset:112
    ds_read_b64_tr_b16 a[4:5], v248 offset:64
    ds_read_b64_tr_b16 a[6:7], v248 offset:176
    ds_read_b64_tr_b16 a[8:9], v248 offset:96
    ds_read_b64_tr_b16 a[10:11], v248 offset:208
    ds_read_b64_tr_b16 a[12:13], v250 offset:3584
    ds_read_b64_tr_b16 a[14:15], v250 offset:3696
    ds_read_b64_tr_b16 a[16:17], v248 offset:3648
    ds_read_b64_tr_b16 a[18:19], v248 offset:3760
    ds_read_b64_tr_b16 a[20:21], v248 offset:3680
    ds_read_b64_tr_b16 a[22:23], v248 offset:3792
    ds_read_b64_tr_b16 a[24:25], v250 offset:7168
    ds_read_b64_tr_b16 a[26:27], v250 offset:7280
    ds_read_b64_tr_b16 a[28:29], v248 offset:7232
    v_and_b32 v153, 1, v2
    v_lshl_add_u32 v144, v153, 9, v1
    s_lshl_b32 s20, s34, 6
    s_add_u32 s20, s20, 1536
    s_and_b32 s38, s2, 1
    s_lshl_b32 s38, s38, 8
    s_add_u32 s29, s38, 2560
    s_mov_b32 s56, s4
    s_mov_b32 s57, s5
    s_mov_b32 s59, 0x20000
    s_cmp_ge_u32 s2, 224
    s_cselect_b32 s20, s29, s20
    ds_read_b64_tr_b16 a[30:31], v248 offset:7344
    ds_read_b64_tr_b16 a[32:33], v248 offset:7264
    ds_read_b64_tr_b16 a[34:35], v248 offset:7376
    s_waitcnt lgkmcnt(12)
    v_mfma_f32_16x16x32_bf16 v[24:27], a[4:7], a[0:3], 0
    ds_read_b64_tr_b16 a[36:37], v250 offset:10752
    ds_read_b64_tr_b16 a[38:39], v250 offset:10864
    ds_read_b64_tr_b16 a[40:41], v248 offset:10816
    s_cselect_b32 s58, 0, 18874368
    s_cselect_b64 vcc, -1, 0
    v_cndmask_b32 v144, v144, v0, vcc
    v_mfma_f32_16x16x32_bf16 v[28:31], a[8:11], a[0:3], 0
    ds_read_b64_tr_b16 a[42:43], v248 offset:10928
    ds_read_b64_tr_b16 a[44:45], v248 offset:10848
    ds_read_b64_tr_b16 a[46:47], v248 offset:10960
    v_add_lshl_u32 v144, s20, v144, 2
    v_add_u32 v144, 4194304, v144
    v_add_u32 v145, 12288, v144
    s_waitcnt lgkmcnt(12)
    v_mfma_f32_16x16x32_bf16 v[24:27], a[16:19], a[12:15], v[24:27]
    ds_read_b64_tr_b16 a[48:49], v250 offset:14592
    ds_read_b64_tr_b16 a[50:51], v250 offset:14704
    ds_read_b64_tr_b16 a[52:53], v248 offset:14656
    v_add_u32 v146, 24576, v144
    v_add_u32 v147, 36864, v144
    v_cvt_f32_u32 v153, v153
    v_mfma_f32_16x16x32_bf16 v[28:31], a[20:23], a[12:15], v[28:31]
    ds_read_b64_tr_b16 a[54:55], v248 offset:14768
    ds_read_b64_tr_b16 a[56:57], v248 offset:14688
    ds_read_b64_tr_b16 a[58:59], v248 offset:14800
    s_mul_i32 s20, s22, 4112
    s_add_u32 s20, s20, 67584
    v_lshl_add_u32 v148, v1, 3, s20
    s_waitcnt lgkmcnt(12)
    v_mfma_f32_16x16x32_bf16 v[24:27], a[28:31], a[24:27], v[24:27]
    ds_read_b64_tr_b16 a[60:61], v250 offset:18176
    ds_read_b64_tr_b16 a[62:63], v250 offset:18288
    ds_read_b64_tr_b16 a[64:65], v248 offset:18240
    s_lshl_b32 s20, s35, 2
    s_add_u32 s20, s20, s22
    s_lshl_b32 s20, s20, 1
    v_mfma_f32_16x16x32_bf16 v[28:31], a[32:35], a[24:27], v[28:31]
    ds_read_b64_tr_b16 a[66:67], v248 offset:18352
    ds_read_b64_tr_b16 a[68:69], v248 offset:18272
    ds_read_b64_tr_b16 a[70:71], v248 offset:18384
    s_mul_i32 s29, s20, 4682
    s_lshr_b32 s29, s29, 16
    s_mul_i32 s29, s29, 210
    s_waitcnt lgkmcnt(12)
    v_mfma_f32_16x16x32_bf16 v[24:27], a[40:43], a[36:39], v[24:27]
    ds_read_b64_tr_b16 a[72:73], v250 offset:21760
    ds_read_b64_tr_b16 a[74:75], v250 offset:21872
    ds_read_b64_tr_b16 a[76:77], v248 offset:21824
    s_add_u32 s29, s29, s20
    s_mul_i32 s21, s34, 28
    s_add_u32 s29, s29, s21
    v_mfma_f32_16x16x32_bf16 v[28:31], a[44:47], a[36:39], v[28:31]
    ds_read_b64_tr_b16 a[78:79], v248 offset:21936
    ds_read_b64_tr_b16 a[80:81], v248 offset:21856
    ds_read_b64_tr_b16 a[82:83], v248 offset:21968
    s_lshl_b32 s29, s29, 11
    s_add_u32 s29, s29, 10485760
    v_lshl_add_u32 v149, v15, 8, v6
    s_waitcnt lgkmcnt(12)
    v_mfma_f32_16x16x32_bf16 v[24:27], a[52:55], a[48:51], v[24:27]
    ds_read_b64_tr_b16 a[84:85], v250 offset:25344
    ds_read_b64_tr_b16 a[86:87], v250 offset:25456
    ds_read_b64_tr_b16 a[88:89], v248 offset:25408
    v_add_u32 v149, s29, v149
    v_add_u32 v150, 28672, v149
    s_lshl_b32 s20, s20, 11
    v_mfma_f32_16x16x32_bf16 v[28:31], a[56:59], a[48:51], v[28:31]
    ds_read_b64_tr_b16 a[90:91], v248 offset:25520
    ds_read_b64_tr_b16 a[92:93], v248 offset:25440
    ds_read_b64_tr_b16 a[94:95], v248 offset:25552
    s_lshr_b32 s21, s34, 1
    s_lshl_b32 s21, s21, 9
    s_add_u32 s20, s20, s21
    s_waitcnt lgkmcnt(12)
    v_mfma_f32_16x16x32_bf16 v[24:27], a[64:67], a[60:63], v[24:27]
    s_and_b32 s21, s34, 1
    s_lshl_b32 s21, s21, 3
    s_add_u32 s20, s20, s21
    v_mfma_f32_16x16x32_bf16 v[28:31], a[68:71], a[60:63], v[28:31]
    s_add_u32 s20, s20, 4718592
    v_add_u32 v151, s20, v6
    s_lshl_b32 s20, s2, 9
    s_waitcnt lgkmcnt(6)
    v_mfma_f32_16x16x32_bf16 v[24:27], a[76:79], a[72:75], v[24:27]
    s_add_u32 s20, s20, 4325376
    v_add_u32 v152, s20, v6
    s_lshl_b32 s20, s2, 7
    v_mfma_f32_16x16x32_bf16 v[28:31], a[80:83], a[72:75], v[28:31]
    s_add_u32 s20, s20, 4456448
    v_mov_b32 v154, s20
    v_cmp_gt_u32 vcc, 32, v1
    s_waitcnt lgkmcnt(0)
    v_mfma_f32_16x16x32_bf16 v[24:27], a[88:91], a[84:87], v[24:27]
    v_cndmask_b32 v152, v154, v152, vcc
    s_lshr_b32 s21, s2, 5
    s_lshl_b32 s20, s21, 7
    v_mfma_f32_16x16x32_bf16 v[28:31], a[92:95], a[84:87], v[28:31]
    s_cmp_eq_u32 s21, 3
    s_cselect_b32 s40, s4, s40
    s_cselect_b32 s41, s5, s41
    s_cselect_b32 s20, 5242880, s20
    s_cselect_b32 s60, 8, 10
    s_xor_b32 s54, s33, 1
    s_mov_b32 s55, 0
    s_mov_b64 exec, s[54:55]
    v_add_f32 v24, s31, v24
    s_mov_b64 exec, -1
    s_lshl_b32 s54, s54, 16
    ds_write2_b32 v244, v24, v25 offset0:0 offset1:1
    ds_write2_b32 v245, v26, v27 offset0:0 offset1:1
    s_mov_b64 exec, 0xffff
    ds_write2_b32 v246, v28, v29 offset0:0 offset1:33
    ds_write2_b32 v246, v30, v31 offset0:66 offset1:99
    s_mov_b64 exec, s[54:55]
    ds_write_b32 v246, v28
    s_mov_b64 exec, -1
    s_cmp_lg_u32 s22, 0
    s_cbranch_scc1 L_f1_go
    s_and_b32 s0, s2, 63
    s_lshl_b32 s0, s0, 7
    s_add_u32 s0, s0, 4259840
    s_mov_b32 s3, 0
L_f1:
    s_load_dword s1, s[4:5], s0 glc
L_f1_t:
    s_add_u32 s3, s3, 1
    s_cmp_gt_u32 s3, 400000
    s_waitcnt lgkmcnt(0)
    s_cbranch_scc1 L_f1_x
    s_cmp_lg_u32 s1, 8
    s_cbranch_scc1 L_f1
L_f1_x:
L_f1_go:
    s_mov_b64 exec, 0
    s_cmp_eq_u32 s22, 1
    s_cbranch_scc1 T_f1_1_0
T_f1_back:
    s_mov_b64 exec, -1
    s_waitcnt lgkmcnt(0)
    s_barrier
    global_load_dwordx4 v[208:211], v251, s[4:5] sc1
    global_load_dword v50, v56, s[4:5] offset:-2048 sc1
    global_load_dword v48, v56, s[4:5] sc1
    global_load_dword v46, v56, s[4:5] offset:2048 sc1
    ds_read2st64_b32 v[64:65], v229 offset0:0 offset1:11
    ds_read2st64_b32 v[66:67], v230 offset0:0 offset1:11
    ds_read2st64_b32 v[68:69], v231 offset0:0 offset1:11
    ds_read2st64_b32 v[70:71], v232 offset0:0 offset1:11
    ds_read2st64_b32 v[72:73], v233 offset0:0 offset1:11
    ds_read2st64_b32 v[74:75], v234 offset0:0 offset1:11
    ds_read2st64_b32 v[76:77], v235 offset0:0 offset1:11
    ds_read2st64_b32 v[78:79], v236 offset0:0 offset1:11
    ds_read2st64_b32 v[80:81], v237 offset0:0 offset1:11
    ds_write_b128 v239, v[52:55] offset:8192
    s_movk_i32 s42, 448
    s_lshl_b32 s42, s42, s60
    s_mul_i32 s21, s22, s42
    s_add_u32 s20, s20, s21
    s_add_u32 s40, s40, s20
    s_addc_u32 s41, s41, 0
    s_lshl_b32 s61, 1, s60
    s_sub_u32 s42, s42, s61
    s_add_u32 s42, s42, 128
    s_mov_b32 s43, 0x20000
    s_lshl_b32 s61, s61, 3
    s_sub_u32 s62, s61, 1024
    v_lshrrev_b32 v240, 3, v1
    v_and_b32 v241, 2, v240
    v_lshlrev_b32 v241, 1, v241
    v_and_b32 v242, 7, v1
    global_load_dwordx4 v[212:215], v252, s[4:5] sc1
    global_load_dword v140, v144, s[4:5] sc1
    global_load_dword v141, v145, s[4:5] sc1
    global_load_dword v142, v146, s[4:5] sc1
    global_load_dword v143, v147, s[4:5] sc1
    s_waitcnt lgkmcnt(1)
    v_cvt_pk_bf16_f32 v24, v64, v66
    v_cvt_pk_bf16_f32 v25, v68, v70
    v_cvt_pk_bf16_f32 v26, v72, v74
    v_cvt_pk_bf16_f32 v27, v76, v78
    ds_write_b128 v5, v[24:27] offset:4096
    v_xor_b32 v241, v241, v242
    v_lshlrev_b32 v240, s60, v240
    v_lshl_add_u32 v240, v241, 4, v240
    v_add_u32 v241, s62, v240
    v_add_u32 v242, s62, v241
    v_add_u32 v243, s62, v242
    v_lshlrev_b32 v154, 2, v1
    v_add_u32 v154, 84032, v154
    v_lshlrev_b32 v155, 1, v1
    v_add_u32 v155, 84288, v155
    v_cvt_pk_bf16_f32 v28, v66, v68
    v_cvt_pk_bf16_f32 v29, v70, v72
    v_cvt_pk_bf16_f32 v30, v74, v76
    v_cvt_pk_bf16_f32 v31, v78, v80
    ds_write_b128 v5, v[28:31] offset:18752
    v_lshlrev_b32 v156, 4, v15
    v_add_u32 v156, 84032, v156
    v_lshlrev_b32 v157, 3, v15
    v_add_u32 v157, 84288, v157
    v_mov_b32 v136, 0x3f803f80
    v_mov_b32 v137, 0x3f803f80
    v_mov_b32 v138, 0x3f803f80
    v_mov_b32 v139, 0x3f803f80
    s_lshl_b32 s20, s23, 1
    s_add_u32 s20, s20, s32
    v_cvt_pk_bf16_f32 v32, v65, v67
    v_cvt_pk_bf16_f32 v33, v69, v71
    v_cvt_pk_bf16_f32 v34, v73, v75
    v_cvt_pk_bf16_f32 v35, v77, v79
    ds_write_b128 v5, v[32:35] offset:33280
    s_and_b32 s21, s20, 7
    s_lshl_b32 s20, s20, 9
    s_lshl_b32 s29, s33, 21
    s_add_u32 s20, s20, s29
    s_add_u32 s20, s20, 6291456
    v_and_b32 v11, 7, v14
    v_xor_b32 v11, s21, v11
    v_lshlrev_b32 v11, 5, v11
    v_and_b32 v9, 2, v15
    v_lshl_add_u32 v11, v9, 3, v11
    v_cvt_pk_bf16_f32 v36, v67, v69
    v_cvt_pk_bf16_f32 v37, v71, v73
    v_cvt_pk_bf16_f32 v38, v75, v77
    v_cvt_pk_bf16_f32 v39, v79, v81
    ds_write_b128 v5, v[36:39] offset:47936
    v_bfe_u32 v9, v1, 3, 2
    v_lshl_add_u32 v11, v9, 18, v11
    v_add_u32 v11, s20, v11
    v_add_u32 v10, 0x100000, v11
    v_add_u32 v8, s45, v6
    s_xor_b32 s20, s22, 1
    s_mul_i32 s20, s20, 14592
    v_add_u32 v9, s20, v6
    v_add_u32 v254, 1024, v253
    s_waitcnt vmcnt(9)
    ds_write2_b32 v253, a128, a132 offset0:0 offset1:1
    ds_write2_b32 v253, a129, a133 offset0:2 offset1:3
    ds_write2_b32 v253, a130, a134 offset0:4 offset1:5
    ds_write2_b32 v253, a131, a135 offset0:6 offset1:7
    ds_write2_b32 v254, a136, a140 offset0:0 offset1:1
    ds_write2_b32 v254, a137, a141 offset0:2 offset1:3
    ds_write2_b32 v254, a138, a142 offset0:4 offset1:5
    ds_write2_b32 v254, a139, a143 offset0:6 offset1:7
    s_waitcnt lgkmcnt(0)
    s_barrier
    ds_read2_b32 a[0:1], v63 offset0:128 offset1:129
    ds_read2_b32 a[2:3], v63 offset0:130 offset1:131
    ds_read2_b32 a[4:5], v63 offset0:0 offset1:1
    ds_read2_b32 a[6:7], v63 offset0:2 offset1:3
    ds_read2_b32 a[8:9], v62 offset0:128 offset1:129
    ds_read2_b32 a[10:11], v62 offset0:130 offset1:131
    ds_read2_b32 a[12:13], v62 offset0:0 offset1:1
    ds_read2_b32 a[14:15], v62 offset0:2 offset1:3
    ds_read2_b32 a[16:17], v61 offset0:128 offset1:129
    ds_read2_b32 a[18:19], v61 offset0:130 offset1:131
    ds_read2_b32 a[20:21], v61 offset0:0 offset1:1
    ds_read2_b32 a[22:23], v61 offset0:2 offset1:3
    ds_read2_b32 a[24:25], v60 offset0:128 offset1:129
    ds_read2_b32 a[26:27], v60 offset0:130 offset1:131
    ds_read2_b32 a[28:29], v60 offset0:0 offset1:1
    ds_read2_b32 a[30:31], v60 offset0:2 offset1:3
    s_lshl_b32 s20, s22, 10
    s_add_u32 m0, s20, 8320
    s_nop 0
    global_load_lds_dwordx4 v238, s[4:5] sc1
    s_add_u32 m0, s20, 22912
    s_nop 0
    global_load_lds_dwordx4 v249, s[4:5] sc1
    s_mul_i32 s63, s2, 56
    v_lshrrev_b32 v255, 2, v0
    v_min_u32 v255, 55, v255
    v_add_lshl_u32 v255, v255, s63, 7
    global_load_dword v255, v255, s[8:9]
    s_waitcnt vmcnt(8)
    v_add_f32_dpp v48, v48, v48 quad_perm:[2,3,0,1] row_mask:0xf bank_mask:0xf
    v_add_f32_dpp v50, v50, v50 quad_perm:[2,3,0,1] row_mask:0xf bank_mask:0xf
    v_add_f32_dpp v46, v46, v46 quad_perm:[2,3,0,1] row_mask:0xf bank_mask:0xf
    v_add_f32_dpp v48, v48, v48 row_ror:4 row_mask:0xf bank_mask:0xf
    v_add_f32_dpp v50, v50, v50 row_ror:4 row_mask:0xf bank_mask:0xf
    v_add_f32_dpp v46, v46, v46 row_ror:4 row_mask:0xf bank_mask:0xf
    v_cvt_pk_bf16_f32 v48, v48, v48
    v_cvt_pk_bf16_f32 v50, v50, v46
    v_lshlrev_b32 v48, 16, v48
    v_and_b32 v46, 0xffff0000, v50
    v_add_f32 v48, 1.0, v48
    v_lshlrev_b32 v50, 16, v50
    v_cvt_pk_bf16_f32 v48, v48, v48
    v_mul_f32 v50, v50, v46
    v_lshlrev_b32 v48, 16, v48
    v_mul_f32 v48, v48, v46
    s_waitcnt vmcnt(11)
    v_lshlrev_b32 v192, 16, v208
    v_and_b32 v193, 0xffff0000, v208
    v_lshlrev_b32 v194, 16, v209
    v_and_b32 v195, 0xffff0000, v209
    v_lshlrev_b32 v196, 16, v210
    v_and_b32 v197, 0xffff0000, v210
    v_lshlrev_b32 v198, 16, v211
    v_and_b32 v199, 0xffff0000, v211
    v_pk_fma_f32 v[192:193], v[192:193], v[48:49], v[50:51] op_sel_hi:[1,0,0]
    v_pk_fma_f32 v[194:195], v[194:195], v[48:49], v[50:51] op_sel_hi:[1,0,0]
    v_pk_fma_f32 v[196:197], v[196:197], v[48:49], v[50:51] op_sel_hi:[1,0,0]
    v_pk_fma_f32 v[198:199], v[198:199], v[48:49], v[50:51] op_sel_hi:[1,0,0]
    v_cvt_pk_bf16_f32 v208, v192, v193
    v_cvt_pk_bf16_f32 v209, v194, v195
    v_cvt_pk_bf16_f32 v210, v196, v197
    v_cvt_pk_bf16_f32 v211, v198, v199
    ds_write_b128 v3, v[208:211] offset:58848
    s_waitcnt vmcnt(7)
    v_lshlrev_b32 v200, 16, v212
    v_and_b32 v201, 0xffff0000, v212
    v_lshlrev_b32 v202, 16, v213
    v_and_b32 v203, 0xffff0000, v213
    v_lshlrev_b32 v204, 16, v214
    v_and_b32 v205, 0xffff0000, v214
    v_lshlrev_b32 v206, 16, v215
    v_and_b32 v207, 0xffff0000, v215
    v_pk_fma_f32 v[200:201], v[200:201], v[48:49], v[50:51] op_sel_hi:[1,0,0]
    v_pk_fma_f32 v[202:203], v[202:203], v[48:49], v[50:51] op_sel_hi:[1,0,0]
T_f1_1_0:
    s_cbranch_execz T_f1_1_1
    v_pk_fma_f32 v[204:205], v[204:205], v[48:49], v[50:51] op_sel_hi:[1,0,0]
    v_pk_fma_f32 v[206:207], v[206:207], v[48:49], v[50:51] op_sel_hi:[1,0,0]
    v_cvt_pk_bf16_f32 v212, v200, v201
    v_cvt_pk_bf16_f32 v213, v202, v203
    v_cvt_pk_bf16_f32 v214, v204, v205
    v_cvt_pk_bf16_f32 v215, v206, v207
    ds_write_b128 v3, v[212:215] offset:60896
    s_waitcnt vmcnt(3)
    v_add_f32 v140, v140, v141
    v_add_f32 v142, v142, v143
    v_add_f32 v140, v140, v142
    v_cvt_pk_bf16_f32 v140, v140, v140
    v_lshlrev_b32 v142, 16, v140
    v_add_f32 v140, v142, v153
    v_cvt_pk_bf16_f32 v140, v140, v140
    v_lshlrev_b32 v141, 16, v140
    s_cmp_eq_u32 s33, 0
    s_cbranch_scc0 L_cb
    ds_write_b16 v155, v140
    s_branch L_md
L_cb:
    ds_write_b32 v154, v141
L_md:
    s_waitcnt lgkmcnt(0)
    s_barrier
    ds_read_b128 a[32:35], v58 offset:58368
    ds_read_b128 a[36:39], v58 offset:58880
    ds_read_b128 a[40:43], v58 offset:59392
    ds_read_b128 a[44:47], v58 offset:59904
    ds_read_b128 a[48:51], v58 offset:60416
    ds_read_b128 a[52:55], v58 offset:60928
T_f1_1_1:
    s_cbranch_execz T_f1_back
    ds_read_b128 a[56:59], v58 offset:61440
    ds_read_b128 a[60:63], v58 offset:61952
    s_cmp_lg_u32 s22, 1
    s_cbranch_scc1 L_noclr
    s_mov_b32 s54, -1
    s_mov_b32 s55, 1
    s_mov_b64 exec, s[54:55]
    global_store_dwordx4 v152, v[52:55], s[4:5] sc1
    s_mov_b64 exec, -1
L_noclr:
    s_lshr_b32 s20, s2, 1
    s_cmp_lg_u32 s20, 112
    s_cbranch_scc1 L_nogate
    v_add_lshl_u32 v143, s38, v0, 2
    v_add_u32 v143, 4243456, v143
    global_store_dword v143, v142, s[4:5] sc1
L_nogate:
    s_waitcnt lgkmcnt(7)
    v_mfma_f32_16x16x32_bf16 v[16:19], a[0:3], a[32:35], 0
    ds_read2_b32 a[64:65], v63 offset0:144 offset1:145
    ds_read2_b32 a[66:67], v63 offset0:146 offset1:147
    v_mfma_f32_16x16x32_bf16 v[20:23], a[4:7], a[32:35], 0
    ds_read_b128 a[96:99], v58 offset:58432
    v_mfma_f32_16x16x32_bf16 v[24:27], a[8:11], a[32:35], 0
    ds_read2_b32 a[68:69], v63 offset0:16 offset1:17
    s_add_u32 m0, s24, 147456
    v_mfma_f32_16x16x32_bf16 v[28:31], a[12:15], a[32:35], 0
    ds_read2_b32 a[70:71], v63 offset0:18 offset1:19
    v_mfma_f32_16x16x32_bf16 v[32:35], a[16:19], a[32:35], 0
    ds_read_b128 a[100:103], v58 offset:58944
    ds_read2_b32 a[72:73], v62 offset0:144 offset1:145
    v_mfma_f32_16x16x32_bf16 v[36:39], a[20:23], a[32:35], 0
    ds_read2_b32 a[74:75], v62 offset0:146 offset1:147
    v_mfma_f32_16x16x32_bf16 v[40:43], a[24:27], a[32:35], 0
    ds_read_b128 a[104:107], v58 offset:59456
    v_mfma_f32_16x16x32_bf16 v[44:47], a[28:31], a[32:35], 0
    ds_read2_b32 a[76:77], v62 offset0:16 offset1:17
    s_mul_i32 s44, s61, 0
    s_waitcnt lgkmcnt(15)
    v_mfma_f32_16x16x32_bf16 v[20:23], a[0:3], a[36:39], v[20:23]
    ds_read2_b32 a[78:79], v62 offset0:18 offset1:19
    v_mfma_f32_16x16x32_bf16 v[24:27], a[4:7], a[36:39], v[24:27]
    ds_read_b128 a[108:111], v58 offset:59968
    ds_read2_b32 a[80:81], v61 offset0:144 offset1:145
    v_mfma_f32_16x16x32_bf16 v[28:31], a[8:11], a[36:39], v[28:31]
    ds_read2_b32 a[82:83], v61 offset0:146 offset1:147
    v_mfma_f32_16x16x32_bf16 v[32:35], a[12:15], a[36:39], v[32:35]
    ds_read_b128 a[112:115], v58 offset:60480
    v_mfma_f32_16x16x32_bf16 v[36:39], a[16:19], a[36:39], v[36:39]
    ds_read2_b32 a[84:85], v61 offset0:16 offset1:17
    buffer_load_dwordx4 v240, s[40:43], s44 offen offset:0 sc1 lds
    v_mfma_f32_16x16x32_bf16 v[40:43], a[20:23], a[36:39], v[40:43]
    ds_read2_b32 a[86:87], v61 offset0:18 offset1:19
    v_mfma_f32_16x16x32_bf16 v[44:47], a[24:27], a[36:39], v[44:47]
    ds_read_b128 a[116:119], v58 offset:60992
    ds_read2_b32 a[88:89], v60 offset0:144 offset1:145
    s_waitcnt lgkmcnt(15)
    v_mfma_f32_16x16x32_bf16 v[24:27], a[0:3], a[40:43], v[24:27]
    ds_read2_b32 a[90:91], v60 offset0:146 offset1:147
    v_mfma_f32_16x16x32_bf16 v[28:31], a[4:7], a[40:43], v[28:31]
    ds_read_b128 a[120:123], v58 offset:61504
    v_mfma_f32_16x16x32_bf16 v[32:35], a[8:11], a[40:43], v[32:35]
    ds_read2_b32 a[92:93], v60 offset0:16 offset1:17
    buffer_load_dwordx4 v241, s[40:43], s44 offen offset:1024 sc1 lds
    v_mfma_f32_16x16x32_bf16 v[36:39], a[12:15], a[40:43], v[36:39]
    ds_read2_b32 a[94:95], v60 offset0:18 offset1:19
    ds_read_b128 a[124:127], v58 offset:62016
    v_mfma_f32_16x16x32_bf16 v[40:43], a[16:19], a[40:43], v[40:43]
    ds_read_b64_tr_b16 v[64:65], v148 offset:0
    v_mfma_f32_16x16x32_bf16 v[44:47], a[20:23], a[40:43], v[44:47]
    ds_read_b64_tr_b16 v[66:67], v148 offset:512
    s_waitcnt lgkmcnt(15)
    v_mfma_f32_16x16x32_bf16 v[28:31], a[0:3], a[44:47], v[28:31]
    ds_read_b64_tr_b16 v[68:69], v148 offset:1024
    buffer_load_dwordx4 v242, s[40:43], s44 offen offset:2048 sc1 lds
    v_mfma_f32_16x16x32_bf16 v[32:35], a[4:7], a[44:47], v[32:35]
    ds_read_b64_tr_b16 v[70:71], v148 offset:1536
    v_mfma_f32_16x16x32_bf16 v[36:39], a[8:11], a[44:47], v[36:39]
    ds_read_b64_tr_b16 v[72:73], v148 offset:2056
    ds_read_b64_tr_b16 v[74:75], v148 offset:2568
    v_mfma_f32_16x16x32_bf16 v[40:43], a[12:15], a[44:47], v[40:43]
    ds_read_b64_tr_b16 v[76:77], v148 offset:3080
    v_mfma_f32_16x16x32_bf16 v[44:47], a[16:19], a[44:47], v[44:47]
    ds_read_b64_tr_b16 v[78:79], v148 offset:3592
    s_waitcnt lgkmcnt(15)
    v_mfma_f32_16x16x32_bf16 v[32:35], a[0:3], a[48:51], v[32:35]
    ds_read_b64 v[80:81], v157 offset:0
    s_mul_i32 s44, s61, 4
    v_mfma_f32_16x16x32_bf16 v[36:39], a[4:7], a[48:51], v[36:39]
    ds_read_b128 v[88:91], v156 offset:0
    v_mfma_f32_16x16x32_bf16 v[40:43], a[8:11], a[48:51], v[40:43]
    ds_read_b64 v[82:83], v157 offset:32
    ds_read_b128 v[92:95], v156 offset:64
    v_mfma_f32_16x16x32_bf16 v[44:47], a[12:15], a[48:51], v[44:47]
    ds_read_b64 v[84:85], v157 offset:64
    s_waitcnt lgkmcnt(15)
    v_mfma_f32_16x16x32_bf16 v[36:39], a[0:3], a[52:55], v[36:39]
    ds_read_b128 v[96:99], v156 offset:128
    v_mfma_f32_16x16x32_bf16 v[40:43], a[4:7], a[52:55], v[40:43]
    ds_read_b64 v[86:87], v157 offset:96
    buffer_load_dwordx4 v243, s[40:43], s44 offen offset:3072 sc1 lds
    v_mfma_f32_16x16x32_bf16 v[44:47], a[8:11], a[52:55], v[44:47]
    ds_read_b128 v[100:103], v156 offset:192
    s_waitcnt lgkmcnt(15)
    v_mfma_f32_16x16x32_bf16 v[40:43], a[0:3], a[56:59], v[40:43]
    v_mfma_f32_16x16x32_bf16 v[44:47], a[4:7], a[56:59], v[44:47]
    s_waitcnt lgkmcnt(15)
    v_mfma_f32_16x16x32_bf16 v[44:47], a[0:3], a[60:63], v[44:47]
    s_waitcnt lgkmcnt(0)
    v_mfma_f32_16x16x32_bf16 v[16:19], a[64:67], a[96:99], v[16:19]
    ds_read2_b32 a[0:1], v63 offset0:160 offset1:161
    v_lshlrev_b32 v104, 16, v64
    v_mfma_f32_16x16x32_bf16 v[20:23], a[68:71], a[96:99], v[20:23]
    ds_read2_b32 a[2:3], v63 offset0:162 offset1:163
    s_add_u32 m0, s24, 90112
    v_and_b32 v105, 0xffff0000, v64
    v_mfma_f32_16x16x32_bf16 v[24:27], a[72:75], a[96:99], v[24:27]
    ds_read_b128 a[32:35], v58 offset:58496
    s_mul_i32 s44, s61, 8
    v_mfma_f32_16x16x32_bf16 v[28:31], a[76:79], a[96:99], v[28:31]
    ds_read2_b32 a[4:5], v63 offset0:32 offset1:33
    buffer_load_dwordx4 v240, s[40:43], s44 offen offset:0 sc1 lds
    v_mfma_f32_16x16x32_bf16 v[32:35], a[80:83], a[96:99], v[32:35]
    ds_read2_b32 a[6:7], v63 offset0:34 offset1:35
    v_lshlrev_b32 v106, 16, v65
    v_mfma_f32_16x16x32_bf16 v[36:39], a[84:87], a[96:99], v[36:39]
    ds_read_b128 a[36:39], v58 offset:59008
    v_and_b32 v107, 0xffff0000, v65
    v_lshlrev_b32 v108, 16, v66
    v_mfma_f32_16x16x32_bf16 v[40:43], a[88:91], a[96:99], v[40:43]
    ds_read2_b32 a[8:9], v62 offset0:160 offset1:161
    v_and_b32 v109, 0xffff0000, v66
    v_mfma_f32_16x16x32_bf16 v[44:47], a[92:95], a[96:99], v[44:47]
    ds_read2_b32 a[10:11], v62 offset0:162 offset1:163
    v_lshlrev_b32 v110, 16, v67
    v_mfma_f32_16x16x32_bf16 v[20:23], a[64:67], a[100:103], v[20:23]
    ds_read_b128 a[40:43], v58 offset:59520
    v_and_b32 v111, 0xffff0000, v67
    v_mfma_f32_16x16x32_bf16 v[24:27], a[68:71], a[100:103], v[24:27]
    ds_read2_b32 a[12:13], v62 offset0:32 offset1:33
    buffer_load_dwordx4 v241, s[40:43], s44 offen offset:1024 sc1 lds
    v_mfma_f32_16x16x32_bf16 v[120:123], v[80:83], v[64:67], 0
    v_mfma_f32_16x16x32_bf16 v[28:31], a[72:75], a[100:103], v[28:31]
    ds_read2_b32 a[14:15], v62 offset0:34 offset1:35
    v_mul_f32 v104, v104, v88
    v_mfma_f32_16x16x32_bf16 v[32:35], a[76:79], a[100:103], v[32:35]
    ds_read_b128 a[44:47], v58 offset:60032
    v_mul_f32 v105, v105, v89
    v_mfma_f32_16x16x32_bf16 v[36:39], a[80:83], a[100:103], v[36:39]
    ds_read2_b32 a[16:17], v61 offset0:160 offset1:161
    v_mul_f32 v106, v106, v90
    v_mul_f32 v107, v107, v91
    v_mfma_f32_16x16x32_bf16 v[40:43], a[84:87], a[100:103], v[40:43]
    ds_read2_b32 a[18:19], v61 offset0:162 offset1:163
    v_mul_f32 v108, v108, v92
    v_mfma_f32_16x16x32_bf16 v[44:47], a[88:91], a[100:103], v[44:47]
    ds_read_b128 a[48:51], v58 offset:60544
    s_mul_i32 s44, s61, 12
    v_mfma_f32_16x16x32_bf16 v[24:27], a[64:67], a[104:107], v[24:27]
    ds_read2_b32 a[20:21], v61 offset0:32 offset1:33
    buffer_load_dwordx4 v242, s[40:43], s44 offen offset:2048 sc1 lds
    v_mfma_f32_16x16x32_bf16 v[28:31], a[68:71], a[104:107], v[28:31]
    ds_read2_b32 a[22:23], v61 offset0:34 offset1:35
    v_mul_f32 v109, v109, v93
    v_mul_f32 v110, v110, v94
    v_mfma_f32_16x16x32_bf16 v[32:35], a[72:75], a[104:107], v[32:35]
    ds_read_b128 a[52:55], v58 offset:61056
    v_mul_f32 v111, v111, v95
    v_mfma_f32_16x16x32_bf16 v[36:39], a[76:79], a[104:107], v[36:39]
    ds_read2_b32 a[24:25], v60 offset0:160 offset1:161
    v_cvt_pk_bf16_f32 v112, v104, v105
    v_mfma_f32_16x16x32_bf16 v[40:43], a[80:83], a[104:107], v[40:43]
    ds_read2_b32 a[26:27], v60 offset0:162 offset1:163
    v_cvt_pk_bf16_f32 v113, v106, v107
    v_cvt_pk_bf16_f32 v114, v108, v109
    v_mfma_f32_16x16x32_bf16 v[44:47], a[84:87], a[104:107], v[44:47]
    ds_read_b128 a[56:59], v58 offset:61568
    v_cvt_pk_bf16_f32 v115, v110, v111
    v_mfma_f32_16x16x32_bf16 v[28:31], a[64:67], a[108:111], v[28:31]
    ds_read2_b32 a[28:29], v60 offset0:32 offset1:33
    buffer_load_dwordx4 v243, s[40:43], s44 offen offset:3072 sc1 lds
    v_mfma_f32_16x16x32_bf16 v[32:35], a[68:71], a[108:111], v[32:35]
    ds_read2_b32 a[30:31], v60 offset0:34 offset1:35
    buffer_store_dwordx4 v[112:115], v149, s[56:59], 0 offen offset:0 sc1
    v_mfma_f32_16x16x32_bf16 v[36:39], a[72:75], a[108:111], v[36:39]
    ds_read_b128 a[60:63], v58 offset:62080
    v_mfma_f32_16x16x32_bf16 v[124:127], v[136:139], v[112:115], 0
    v_lshlrev_b32 v104, 16, v68
    v_mfma_f32_16x16x32_bf16 v[40:43], a[76:79], a[108:111], v[40:43]
    v_and_b32 v105, 0xffff0000, v68
    v_lshlrev_b32 v106, 16, v69
    v_mfma_f32_16x16x32_bf16 v[44:47], a[80:83], a[108:111], v[44:47]
    s_add_u32 m0, s24, 106496
    v_and_b32 v107, 0xffff0000, v69
    v_mfma_f32_16x16x32_bf16 v[32:35], a[64:67], a[112:115], v[32:35]
    s_mul_i32 s44, s61, 16
    v_lshlrev_b32 v108, 16, v70
    v_mfma_f32_16x16x32_bf16 v[36:39], a[68:71], a[112:115], v[36:39]
    buffer_load_dwordx4 v240, s[40:43], s44 offen offset:0 sc1 lds
    v_and_b32 v109, 0xffff0000, v70
    v_lshlrev_b32 v110, 16, v71
    v_mfma_f32_16x16x32_bf16 v[40:43], a[72:75], a[112:115], v[40:43]
    v_and_b32 v111, 0xffff0000, v71
    v_mfma_f32_16x16x32_bf16 v[120:123], v[84:87], v[68:71], v[120:123]
    v_mfma_f32_16x16x32_bf16 v[44:47], a[76:79], a[112:115], v[44:47]
    v_mul_f32 v104, v104, v96
    v_mul_f32 v105, v105, v97
    v_mfma_f32_16x16x32_bf16 v[36:39], a[64:67], a[116:119], v[36:39]
    v_mul_f32 v106, v106, v98
    v_mul_f32 v107, v107, v99
    v_mul_f32 v108, v108, v100
    v_mfma_f32_16x16x32_bf16 v[40:43], a[68:71], a[116:119], v[40:43]
    v_mul_f32 v109, v109, v101
    v_mul_f32 v110, v110, v102
    v_mfma_f32_16x16x32_bf16 v[44:47], a[72:75], a[116:119], v[44:47]
    s_mul_i32 s44, s61, 20
    v_mul_f32 v111, v111, v103
    v_mfma_f32_16x16x32_bf16 v[40:43], a[64:67], a[120:123], v[40:43]
    buffer_load_dwordx4 v241, s[40:43], s44 offen offset:1024 sc1 lds
    v_cvt_pk_bf16_f32 v116, v104, v105
    v_mfma_f32_16x16x32_bf16 v[44:47], a[68:71], a[120:123], v[44:47]
    v_cvt_pk_bf16_f32 v117, v106, v107
    v_cvt_pk_bf16_f32 v118, v108, v109
    v_cvt_pk_bf16_f32 v119, v110, v111
    v_mfma_f32_16x16x32_bf16 v[44:47], a[64:67], a[124:127], v[44:47]
    buffer_store_dwordx4 v[116:119], v150, s[56:59], 0 offen offset:0 sc1
    v_mfma_f32_16x16x32_bf16 v[124:127], v[136:139], v[116:119], v[124:127]
    s_waitcnt lgkmcnt(0)
    v_mfma_f32_16x16x32_bf16 v[16:19], a[0:3], a[32:35], v[16:19]
    ds_read2_b32 a[64:65], v63 offset0:176 offset1:177
    v_lshlrev_b32 v104, 16, v72
    v_mfma_f32_16x16x32_bf16 v[20:23], a[4:7], a[32:35], v[20:23]
    ds_read2_b32 a[66:67], v63 offset0:178 offset1:179
    v_and_b32 v105, 0xffff0000, v72
    v_mfma_f32_16x16x32_bf16 v[24:27], a[8:11], a[32:35], v[24:27]
    ds_read_b128 a[96:99], v58 offset:58560
    v_lshlrev_b32 v106, 16, v73
    v_mfma_f32_16x16x32_bf16 v[28:31], a[12:15], a[32:35], v[28:31]
    ds_read2_b32 a[68:69], v63 offset0:48 offset1:49
    v_and_b32 v107, 0xffff0000, v73
    v_mfma_f32_16x16x32_bf16 v[32:35], a[16:19], a[32:35], v[32:35]
    ds_read2_b32 a[70:71], v63 offset0:50 offset1:51
    v_lshlrev_b32 v108, 16, v74
    v_mfma_f32_16x16x32_bf16 v[36:39], a[20:23], a[32:35], v[36:39]
    ds_read_b128 a[100:103], v58 offset:59072
    v_and_b32 v109, 0xffff0000, v74
    v_mfma_f32_16x16x32_bf16 v[40:43], a[24:27], a[32:35], v[40:43]
    ds_read2_b32 a[72:73], v62 offset0:176 offset1:177
    v_lshlrev_b32 v110, 16, v75
    v_mfma_f32_16x16x32_bf16 v[44:47], a[28:31], a[32:35], v[44:47]
    ds_read2_b32 a[74:75], v62 offset0:178 offset1:179
    v_and_b32 v111, 0xffff0000, v75
    v_mfma_f32_16x16x32_bf16 v[20:23], a[0:3], a[36:39], v[20:23]
    ds_read_b128 a[104:107], v58 offset:59584
    v_mfma_f32_16x16x32_bf16 v[128:131], v[80:83], v[72:75], 0
    v_mfma_f32_16x16x32_bf16 v[24:27], a[4:7], a[36:39], v[24:27]
    ds_read2_b32 a[76:77], v62 offset0:48 offset1:49
    buffer_load_dwordx4 v242, s[40:43], s44 offen offset:2048 sc1 lds
    v_mfma_f32_16x16x32_bf16 v[28:31], a[8:11], a[36:39], v[28:31]
    ds_read2_b32 a[78:79], v62 offset0:50 offset1:51
    v_mul_f32 v104, v104, v88
    v_mfma_f32_16x16x32_bf16 v[32:35], a[12:15], a[36:39], v[32:35]
    ds_read_b128 a[108:111], v58 offset:60096
    v_mul_f32 v105, v105, v89
    v_mfma_f32_16x16x32_bf16 v[36:39], a[16:19], a[36:39], v[36:39]
    ds_read2_b32 a[80:81], v61 offset0:176 offset1:177
    v_mul_f32 v106, v106, v90
    v_mfma_f32_16x16x32_bf16 v[40:43], a[20:23], a[36:39], v[40:43]
    ds_read2_b32 a[82:83], v61 offset0:178 offset1:179
    v_mul_f32 v107, v107, v91
    v_mfma_f32_16x16x32_bf16 v[44:47], a[24:27], a[36:39], v[44:47]
    ds_read_b128 a[112:115], v58 offset:60608
    v_mul_f32 v108, v108, v92
    v_mfma_f32_16x16x32_bf16 v[24:27], a[0:3], a[40:43], v[24:27]
    ds_read2_b32 a[84:85], v61 offset0:48 offset1:49
    v_mul_f32 v109, v109, v93
    v_mfma_f32_16x16x32_bf16 v[28:31], a[4:7], a[40:43], v[28:31]
    ds_read2_b32 a[86:87], v61 offset0:50 offset1:51
    v_mul_f32 v110, v110, v94
    v_mfma_f32_16x16x32_bf16 v[32:35], a[8:11], a[40:43], v[32:35]
    ds_read_b128 a[116:119], v58 offset:61120
    v_mul_f32 v111, v111, v95
    v_mfma_f32_16x16x32_bf16 v[36:39], a[12:15], a[40:43], v[36:39]
    ds_read2_b32 a[88:89], v60 offset0:176 offset1:177
    v_cvt_pk_bf16_f32 v112, v104, v105
    v_mfma_f32_16x16x32_bf16 v[40:43], a[16:19], a[40:43], v[40:43]
    ds_read2_b32 a[90:91], v60 offset0:178 offset1:179
    v_cvt_pk_bf16_f32 v113, v106, v107
    v_mfma_f32_16x16x32_bf16 v[44:47], a[20:23], a[40:43], v[44:47]
    ds_read_b128 a[120:123], v58 offset:61632
    v_cvt_pk_bf16_f32 v114, v108, v109
    v_mfma_f32_16x16x32_bf16 v[28:31], a[0:3], a[44:47], v[28:31]
    ds_read2_b32 a[92:93], v60 offset0:48 offset1:49
    v_cvt_pk_bf16_f32 v115, v110, v111
    v_mfma_f32_16x16x32_bf16 v[32:35], a[4:7], a[44:47], v[32:35]
    ds_read2_b32 a[94:95], v60 offset0:50 offset1:51
    buffer_store_dwordx4 v[112:115], v149, s[56:59], 0 offen offset:2048 sc1
    v_mfma_f32_16x16x32_bf16 v[36:39], a[8:11], a[44:47], v[36:39]
    ds_read_b128 a[124:127], v58 offset:62144
    v_mfma_f32_16x16x32_bf16 v[132:135], v[136:139], v[112:115], 0
    v_mfma_f32_16x16x32_bf16 v[40:43], a[12:15], a[44:47], v[40:43]
    v_lshlrev_b32 v104, 16, v76
    v_and_b32 v105, 0xffff0000, v76
    v_mfma_f32_16x16x32_bf16 v[44:47], a[16:19], a[44:47], v[44:47]
    v_lshlrev_b32 v106, 16, v77
    v_and_b32 v107, 0xffff0000, v77
    v_mfma_f32_16x16x32_bf16 v[32:35], a[0:3], a[48:51], v[32:35]
    v_lshlrev_b32 v108, 16, v78
    v_and_b32 v109, 0xffff0000, v78
    v_mfma_f32_16x16x32_bf16 v[36:39], a[4:7], a[48:51], v[36:39]
    buffer_load_dwordx4 v243, s[40:43], s44 offen offset:3072 sc1 lds
    v_lshlrev_b32 v110, 16, v79
    v_mfma_f32_16x16x32_bf16 v[40:43], a[8:11], a[48:51], v[40:43]
    v_and_b32 v111, 0xffff0000, v79
    v_mfma_f32_16x16x32_bf16 v[128:131], v[84:87], v[76:79], v[128:131]
    v_mfma_f32_16x16x32_bf16 v[44:47], a[12:15], a[48:51], v[44:47]
    v_mul_f32 v104, v104, v96
    v_mul_f32 v105, v105, v97
    v_mfma_f32_16x16x32_bf16 v[36:39], a[0:3], a[52:55], v[36:39]
    v_mul_f32 v106, v106, v98
    v_mul_f32 v107, v107, v99
    v_mfma_f32_16x16x32_bf16 v[40:43], a[4:7], a[52:55], v[40:43]
    v_mul_f32 v108, v108, v100
    v_mul_f32 v109, v109, v101
    v_mfma_f32_16x16x32_bf16 v[44:47], a[8:11], a[52:55], v[44:47]
    v_mul_f32 v110, v110, v102
    v_mul_f32 v111, v111, v103
    v_mfma_f32_16x16x32_bf16 v[40:43], a[0:3], a[56:59], v[40:43]
    v_cvt_pk_bf16_f32 v116, v104, v105
    v_cvt_pk_bf16_f32 v117, v106, v107
    v_mfma_f32_16x16x32_bf16 v[44:47], a[4:7], a[56:59], v[44:47]
    v_cvt_pk_bf16_f32 v118, v108, v109
    v_cvt_pk_bf16_f32 v119, v110, v111
    v_mfma_f32_16x16x32_bf16 v[44:47], a[0:3], a[60:63], v[44:47]
    buffer_store_dwordx4 v[116:119], v150, s[56:59], 0 offen offset:2048 sc1
    v_mfma_f32_16x16x32_bf16 v[132:135], v[136:139], v[116:119], v[132:135]
    s_waitcnt vmcnt(17) lgkmcnt(0)
    s_barrier
    s_cmp_eq_u32 s33, 0
    s_cbranch_scc0 L_x1
    v_mfma_f32_16x16x32_bf16 v[32:35], a[64:67], a[112:115], v[32:35]
    ds_read_b64 v[216:217], v59 offset:8320
    v_mfma_f32_16x16x32_bf16 v[32:35], a[68:71], a[108:111], v[32:35]
    ds_read_b64 v[218:219], v59 offset:9344
    v_mfma_f32_16x16x32_bf16 v[32:35], a[72:75], a[104:107], v[32:35]
    ds_read_b64 v[220:221], v59 offset:10368
    v_mfma_f32_16x16x32_bf16 v[32:35], a[76:79], a[100:103], v[32:35]
    ds_read_b64 v[222:223], v59 offset:11392
    v_mfma_f32_16x16x32_bf16 v[32:35], a[80:83], a[96:99], v[32:35]
    v_cvt_pk_bf16_f32 v104, v124, v120
    v_lshlrev_b32 v108, 16, v104
    v_mfma_f32_16x16x32_bf16 v[36:39], a[64:67], a[116:119], v[36:39]
    v_and_b32 v109, 0xffff0000, v104
    v_mfma_f32_16x16x32_bf16 v[36:39], a[68:71], a[112:115], v[36:39]
    v_sub_f32 v124, v124, v108
    v_sub_f32 v120, v120, v109
    v_mfma_f32_16x16x32_bf16 v[36:39], a[72:75], a[108:111], v[36:39]
    v_cvt_pk_bf16_f32 v105, v124, v120
    v_mfma_f32_16x16x32_bf16 v[36:39], a[76:79], a[104:107], v[36:39]
    s_mov_b64 exec, 0xffff
    buffer_store_dwordx2 v[104:105], v151, s[56:59], 0 offen offset:0 sc1
    s_mov_b64 exec, -1
    v_cvt_pk_bf16_f32 v106, v132, v128
    v_mfma_f32_16x16x32_bf16 v[36:39], a[80:83], a[100:103], v[36:39]
    v_lshlrev_b32 v108, 16, v106
    v_mfma_f32_16x16x32_bf16 v[36:39], a[84:87], a[96:99], v[36:39]
    v_and_b32 v109, 0xffff0000, v106
    v_sub_f32 v132, v132, v108
    v_mfma_f32_16x16x32_bf16 v[40:43], a[64:67], a[120:123], v[40:43]
    v_sub_f32 v128, v128, v109
    v_mfma_f32_16x16x32_bf16 v[40:43], a[68:71], a[116:119], v[40:43]
    v_cvt_pk_bf16_f32 v107, v132, v128
    s_mov_b64 exec, 0xffff
    buffer_store_dwordx2 v[106:107], v151, s[56:59], 0 offen offset:2048 sc1
    s_mov_b64 exec, -1
    v_mfma_f32_16x16x32_bf16 v[40:43], a[72:75], a[112:115], v[40:43]
    s_waitcnt lgkmcnt(0)
    v_lshlrev_b32 v192, 16, v216
    v_mfma_f32_16x16x32_bf16 v[40:43], a[76:79], a[108:111], v[40:43]
    v_and_b32 v193, 0xffff0000, v216
    v_mfma_f32_16x16x32_bf16 v[40:43], a[80:83], a[104:107], v[40:43]
    v_lshlrev_b32 v194, 16, v217
    v_and_b32 v195, 0xffff0000, v217
    v_mfma_f32_16x16x32_bf16 v[40:43], a[84:87], a[100:103], v[40:43]
    v_lshlrev_b32 v196, 16, v218
    v_mfma_f32_16x16x32_bf16 v[40:43], a[88:91], a[96:99], v[40:43]
    v_and_b32 v197, 0xffff0000, v218
    v_lshlrev_b32 v198, 16, v219
    v_mfma_f32_16x16x32_bf16 v[44:47], a[64:67], a[124:127], v[44:47]
    v_and_b32 v199, 0xffff0000, v219
    v_mfma_f32_16x16x32_bf16 v[44:47], a[68:71], a[120:123], v[44:47]
    v_lshlrev_b32 v200, 16, v220
    v_and_b32 v201, 0xffff0000, v220
    v_mfma_f32_16x16x32_bf16 v[44:47], a[72:75], a[116:119], v[44:47]
    v_lshlrev_b32 v202, 16, v221
    v_mfma_f32_16x16x32_bf16 v[44:47], a[76:79], a[112:115], v[44:47]
    v_and_b32 v203, 0xffff0000, v221
    v_lshlrev_b32 v204, 16, v222
    v_mfma_f32_16x16x32_bf16 v[44:47], a[80:83], a[108:111], v[44:47]
    v_and_b32 v205, 0xffff0000, v222
    v_mfma_f32_16x16x32_bf16 v[44:47], a[84:87], a[104:107], v[44:47]
    v_lshlrev_b32 v206, 16, v223
    v_and_b32 v207, 0xffff0000, v223
    ds_write_b128 v8, v[32:35] offset:0
    v_mfma_f32_16x16x32_bf16 v[44:47], a[88:91], a[100:103], v[44:47]
    v_mfma_f32_16x16x32_bf16 v[44:47], a[92:95], a[96:99], v[44:47]
    v_mfma_f32_16x16x32_bf16 v[16:19], a[64:67], a[96:99], v[16:19]
    ds_write_b128 v8, v[36:39] offset:1024
    v_mfma_f32_16x16x32_bf16 v[20:23], a[64:67], a[100:103], v[20:23]
    v_mfma_f32_16x16x32_bf16 v[20:23], a[68:71], a[96:99], v[20:23]
    v_mfma_f32_16x16x32_bf16 v[24:27], a[64:67], a[104:107], v[24:27]
    ds_write_b128 v8, v[40:43] offset:2048
    v_mfma_f32_16x16x32_bf16 v[24:27], a[68:71], a[100:103], v[24:27]
    v_mfma_f32_16x16x32_bf16 v[24:27], a[72:75], a[96:99], v[24:27]
    v_mfma_f32_16x16x32_bf16 v[28:31], a[64:67], a[108:111], v[28:31]
    ds_write_b128 v8, v[44:47] offset:3072
    v_mfma_f32_16x16x32_bf16 v[28:31], a[68:71], a[104:107], v[28:31]
    v_mfma_f32_16x16x32_bf16 v[28:31], a[72:75], a[100:103], v[28:31]
    v_mfma_f32_16x16x32_bf16 v[28:31], a[76:79], a[96:99], v[28:31]
    s_waitcnt lgkmcnt(0)
    s_barrier
    ds_read_b128 v[64:67], v9 offset:0
    ds_read_b128 v[68:71], v9 offset:1024
    ds_read_b128 v[72:75], v9 offset:2048
    ds_read_b128 v[76:79], v9 offset:3072
    v_pk_add_f32 v[16:17], v[16:17], v[192:193]
    v_pk_add_f32 v[18:19], v[18:19], v[194:195]
    v_pk_add_f32 v[20:21], v[20:21], v[196:197]
    v_pk_add_f32 v[22:23], v[22:23], v[198:199]
    v_pk_add_f32 v[24:25], v[24:25], v[200:201]
    v_pk_add_f32 v[26:27], v[26:27], v[202:203]
    v_pk_add_f32 v[28:29], v[28:29], v[204:205]
    v_pk_add_f32 v[30:31], v[30:31], v[206:207]
    s_waitcnt lgkmcnt(3)
    v_pk_add_f32 v[16:17], v[16:17], v[64:65]
    v_pk_add_f32 v[18:19], v[18:19], v[66:67]
    v_cvt_pk_bf16_f32 v96, v16, v17
    v_cvt_pk_bf16_f32 v97, v18, v19
    s_waitcnt lgkmcnt(2)
    v_pk_add_f32 v[20:21], v[20:21], v[68:69]
    v_pk_add_f32 v[22:23], v[22:23], v[70:71]
    v_cvt_pk_bf16_f32 v98, v20, v21
    v_cvt_pk_bf16_f32 v99, v22, v23
    s_nop 0
    v_permlane16_swap_b32 v96, v98
    v_permlane16_swap_b32 v97, v99
    global_store_dwordx4 v11, v[96:99], s[4:5] sc1
    s_waitcnt lgkmcnt(1)
    v_pk_add_f32 v[24:25], v[24:25], v[72:73]
    v_pk_add_f32 v[26:27], v[26:27], v[74:75]
    v_cvt_pk_bf16_f32 v100, v24, v25
    v_cvt_pk_bf16_f32 v101, v26, v27
    s_waitcnt lgkmcnt(0)
    v_pk_add_f32 v[28:29], v[28:29], v[76:77]
    v_pk_add_f32 v[30:31], v[30:31], v[78:79]
    v_cvt_pk_bf16_f32 v102, v28, v29
    v_cvt_pk_bf16_f32 v103, v30, v31
    s_nop 0
    v_permlane16_swap_b32 v100, v102
    v_permlane16_swap_b32 v101, v103
    global_store_dwordx4 v10, v[100:103], s[4:5] sc1
    s_branch L_x2
L_x1:
    v_mfma_f32_16x16x32_bf16 v[16:19], a[64:67], a[96:99], v[16:19]
    ds_read_b64 v[216:217], v59 offset:8320
    v_mfma_f32_16x16x32_bf16 v[20:23], a[64:67], a[100:103], v[20:23]
    ds_read_b64 v[218:219], v59 offset:9344
    v_mfma_f32_16x16x32_bf16 v[20:23], a[68:71], a[96:99], v[20:23]
    ds_read_b64 v[220:221], v59 offset:10368
    v_mfma_f32_16x16x32_bf16 v[24:27], a[64:67], a[104:107], v[24:27]
    ds_read_b64 v[222:223], v59 offset:11392
    v_mfma_f32_16x16x32_bf16 v[24:27], a[68:71], a[100:103], v[24:27]
    v_cvt_pk_bf16_f32 v104, v124, v120
    v_lshlrev_b32 v108, 16, v104
    v_mfma_f32_16x16x32_bf16 v[24:27], a[72:75], a[96:99], v[24:27]
    v_and_b32 v109, 0xffff0000, v104
    v_mfma_f32_16x16x32_bf16 v[28:31], a[64:67], a[108:111], v[28:31]
    v_sub_f32 v124, v124, v108
    v_sub_f32 v120, v120, v109
    v_mfma_f32_16x16x32_bf16 v[28:31], a[68:71], a[104:107], v[28:31]
    v_cvt_pk_bf16_f32 v105, v124, v120
    v_mfma_f32_16x16x32_bf16 v[28:31], a[72:75], a[100:103], v[28:31]
    s_mov_b64 exec, 0xffff
    buffer_store_dwordx2 v[104:105], v151, s[56:59], 0 offen offset:0 sc1
    s_mov_b64 exec, -1
    v_cvt_pk_bf16_f32 v106, v132, v128
    v_mfma_f32_16x16x32_bf16 v[28:31], a[76:79], a[96:99], v[28:31]
    v_lshlrev_b32 v108, 16, v106
    v_mfma_f32_16x16x32_bf16 v[32:35], a[64:67], a[112:115], v[32:35]
    v_and_b32 v109, 0xffff0000, v106
    v_sub_f32 v132, v132, v108
    v_mfma_f32_16x16x32_bf16 v[32:35], a[68:71], a[108:111], v[32:35]
    v_sub_f32 v128, v128, v109
    v_mfma_f32_16x16x32_bf16 v[32:35], a[72:75], a[104:107], v[32:35]
    v_cvt_pk_bf16_f32 v107, v132, v128
    s_mov_b64 exec, 0xffff
    buffer_store_dwordx2 v[106:107], v151, s[56:59], 0 offen offset:2048 sc1
    s_mov_b64 exec, -1
    v_mfma_f32_16x16x32_bf16 v[32:35], a[76:79], a[100:103], v[32:35]
    s_waitcnt lgkmcnt(0)
    v_lshlrev_b32 v192, 16, v216
    v_mfma_f32_16x16x32_bf16 v[32:35], a[80:83], a[96:99], v[32:35]
    v_and_b32 v193, 0xffff0000, v216
    v_mfma_f32_16x16x32_bf16 v[36:39], a[64:67], a[116:119], v[36:39]
    v_lshlrev_b32 v194, 16, v217
    v_and_b32 v195, 0xffff0000, v217
    v_mfma_f32_16x16x32_bf16 v[36:39], a[68:71], a[112:115], v[36:39]
    v_lshlrev_b32 v196, 16, v218
    v_mfma_f32_16x16x32_bf16 v[36:39], a[72:75], a[108:111], v[36:39]
    v_and_b32 v197, 0xffff0000, v218
    v_lshlrev_b32 v198, 16, v219
    v_mfma_f32_16x16x32_bf16 v[36:39], a[76:79], a[104:107], v[36:39]
    v_and_b32 v199, 0xffff0000, v219
    v_mfma_f32_16x16x32_bf16 v[36:39], a[80:83], a[100:103], v[36:39]
    v_lshlrev_b32 v200, 16, v220
    v_and_b32 v201, 0xffff0000, v220
    v_mfma_f32_16x16x32_bf16 v[36:39], a[84:87], a[96:99], v[36:39]
    v_lshlrev_b32 v202, 16, v221
    v_mfma_f32_16x16x32_bf16 v[40:43], a[64:67], a[120:123], v[40:43]
    v_and_b32 v203, 0xffff0000, v221
    v_lshlrev_b32 v204, 16, v222
    v_mfma_f32_16x16x32_bf16 v[40:43], a[68:71], a[116:119], v[40:43]
    v_and_b32 v205, 0xffff0000, v222
    v_mfma_f32_16x16x32_bf16 v[40:43], a[72:75], a[112:115], v[40:43]
    v_lshlrev_b32 v206, 16, v223
    v_and_b32 v207, 0xffff0000, v223
    ds_write_b128 v8, v[16:19] offset:0
    v_mfma_f32_16x16x32_bf16 v[40:43], a[76:79], a[108:111], v[40:43]
    v_mfma_f32_16x16x32_bf16 v[40:43], a[80:83], a[104:107], v[40:43]
    v_mfma_f32_16x16x32_bf16 v[40:43], a[84:87], a[100:103], v[40:43]
    ds_write_b128 v8, v[20:23] offset:1024
    v_mfma_f32_16x16x32_bf16 v[40:43], a[88:91], a[96:99], v[40:43]
    v_mfma_f32_16x16x32_bf16 v[44:47], a[64:67], a[124:127], v[44:47]
    v_mfma_f32_16x16x32_bf16 v[44:47], a[68:71], a[120:123], v[44:47]
    ds_write_b128 v8, v[24:27] offset:2048
    v_mfma_f32_16x16x32_bf16 v[44:47], a[72:75], a[116:119], v[44:47]
    v_mfma_f32_16x16x32_bf16 v[44:47], a[76:79], a[112:115], v[44:47]
    v_mfma_f32_16x16x32_bf16 v[44:47], a[80:83], a[108:111], v[44:47]
    ds_write_b128 v8, v[28:31] offset:3072
    v_mfma_f32_16x16x32_bf16 v[44:47], a[84:87], a[104:107], v[44:47]
    v_mfma_f32_16x16x32_bf16 v[44:47], a[88:91], a[100:103], v[44:47]
    v_mfma_f32_16x16x32_bf16 v[44:47], a[92:95], a[96:99], v[44:47]
    s_waitcnt lgkmcnt(0)
    s_barrier
    ds_read_b128 v[64:67], v9 offset:0
    ds_read_b128 v[68:71], v9 offset:1024
    ds_read_b128 v[72:75], v9 offset:2048
    ds_read_b128 v[76:79], v9 offset:3072
    v_pk_add_f32 v[32:33], v[32:33], v[192:193]
    v_pk_add_f32 v[34:35], v[34:35], v[194:195]
    v_pk_add_f32 v[36:37], v[36:37], v[196:197]
    v_pk_add_f32 v[38:39], v[38:39], v[198:199]
    v_pk_add_f32 v[40:41], v[40:41], v[200:201]
T_f2_1_0:
    s_cbranch_execz T_f2_1_1
    v_pk_add_f32 v[42:43], v[42:43], v[202:203]
    v_pk_add_f32 v[44:45], v[44:45], v[204:205]
    v_pk_add_f32 v[46:47], v[46:47], v[206:207]
    s_waitcnt lgkmcnt(3)
    v_pk_add_f32 v[32:33], v[32:33], v[64:65]
    v_pk_add_f32 v[34:35], v[34:35], v[66:67]
    v_cvt_pk_bf16_f32 v96, v32, v33
    v_cvt_pk_bf16_f32 v97, v34, v35
    s_waitcnt lgkmcnt(2)
    v_pk_add_f32 v[36:37], v[36:37], v[68:69]
    v_pk_add_f32 v[38:39], v[38:39], v[70:71]
    v_cvt_pk_bf16_f32 v98, v36, v37
    v_cvt_pk_bf16_f32 v99, v38, v39
    s_nop 0
    v_permlane16_swap_b32 v96, v98
    v_permlane16_swap_b32 v97, v99
    global_store_dwordx4 v11, v[96:99], s[4:5] sc1
    s_waitcnt lgkmcnt(1)
    v_pk_add_f32 v[40:41], v[40:41], v[72:73]
    v_pk_add_f32 v[42:43], v[42:43], v[74:75]
    v_cvt_pk_bf16_f32 v100, v40, v41
    v_cvt_pk_bf16_f32 v101, v42, v43
    s_waitcnt lgkmcnt(0)
    v_pk_add_f32 v[44:45], v[44:45], v[76:77]
    v_pk_add_f32 v[46:47], v[46:47], v[78:79]
    v_cvt_pk_bf16_f32 v102, v44, v45
    v_cvt_pk_bf16_f32 v103, v46, v47
T_f2_1_1:
    s_cbranch_execz T_f2_1_2
    s_nop 0
    v_permlane16_swap_b32 v100, v102
    v_permlane16_swap_b32 v101, v103
    global_store_dwordx4 v10, v[100:103], s[4:5] sc1
L_x2:
    s_add_u32 m0, s24, 57344
    v_mov_b32 v3, v6
    v_mov_b32 v252, v14
    v_mov_b32 v253, v15
    v_bfe_u32 v7, v1, 2, 2
    v_lshlrev_b32 v7, 7, v7
    s_mul_i32 s44, s61, 28
    v_lshl_add_u32 v7, v253, 10, v7
    v_and_b32 v9, 3, v1
    v_lshl_add_u32 v7, v9, 4, v7
    v_and_b32 v9, 8, v1
    v_lshl_add_u32 v7, v9, 3, v7
    buffer_load_dwordx4 v240, s[40:43], s44 offen offset:0 sc1 lds
    v_add_u32 v7, s24, v7
    v_xor_b32 v9, 64, v7
    s_and_b32 s16, s2, 1
    s_lshl_b32 s16, s16, 3
    s_bfe_u32 s17, s2, 0x30003
    buffer_load_dwordx4 v241, s[40:43], s44 offen offset:1024 sc1 lds
    s_add_u32 s16, s16, s17
    s_and_b32 s17, s2, 6
    s_lshl_b32 s17, s17, 1
    s_lshr_b32 s25, s2, 6
    buffer_load_dwordx4 v242, s[40:43], s44 offen offset:2048 sc1 lds
    s_add_u32 s17, s17, s25
    s_lshl_b32 s18, s16, 18
    s_add_u32 s18, s18, s24
    s_add_u32 s18, s18, 6291456
    s_mul_i32 s19, s17, 458752
    s_mul_i32 s44, s61, 32
    s_lshl_b32 s25, s22, 13
    s_add_u32 s19, s19, s25
    s_add_u32 s19, s19, 10485760
    s_lshl_b32 s23, s22, 11
    s_mul_i32 s29, s22, 3072
    buffer_load_dwordx4 v243, s[40:43], s44 offen offset:3072 sc1 lds
    s_add_u32 s29, s29, 16384
    s_sub_u32 s56, 32768, s23
    v_lshl_add_u32 v4, v253, 8, v3
    v_add_u32 v5, 1024, v4
    s_add_u32 m0, s24, 73728
    v_add_u32 v6, 2048, v4
    v_add_u32 v238, 3072, v4
    s_add_u32 s8, s4, s18
    s_addc_u32 s9, s5, 0
    s_sub_u32 s10, 262144, s24
    s_mov_b32 s11, 0x20000
    s_mul_i32 s44, s61, 36
    s_add_u32 s12, s4, s19
    s_addc_u32 s13, s5, 0
    s_sub_u32 s14, 458752, s25
    s_mov_b32 s15, 0x20000
    s_and_b32 s28, s2, 6
    s_and_b32 s33, s2, 2
    buffer_load_dwordx4 v240, s[40:43], s44 offen offset:0 sc1 lds
    s_and_b32 s32, s2, 4
    s_lshl1_add_u32 s33, s32, s33
    s_and_b32 s30, s22, 1
    s_lshl_b32 s31, s22, 1
    s_and_b32 s32, s17, 1
    buffer_load_dwordx4 v241, s[40:43], s44 offen offset:1024 sc1 lds
    s_or_b32 s31, s31, s32
    v_lshrrev_b32 v8, 2, v1
    v_and_b32 v14, 7, v8
    v_xor_b32 v14, s31, v14
    s_mul_i32 s44, s61, 40
    v_lshlrev_b32 v8, 8, v8
    v_and_b32 v15, 3, v1
    v_lshl_add_u32 v8, v15, 3, v8
    v_cmp_eq_u32 s[46:47], 1, v15
    v_cmp_eq_u32 s[48:49], 2, v15
    buffer_load_dwordx4 v242, s[40:43], s44 offen offset:2048 sc1 lds
    v_cmp_eq_u32 s[50:51], 3, v15
    v_xor_b32 v15, 0, v14
    v_lshl_add_u32 v10, v15, 5, v8
    v_xor_b32 v15, 1, v14
    v_lshl_add_u32 v11, v15, 5, v8
    buffer_load_dwordx4 v243, s[40:43], s44 offen offset:3072 sc1 lds
    v_xor_b32 v15, 2, v14
    v_lshl_add_u32 v12, v15, 5, v8
    v_xor_b32 v15, 3, v14
    v_lshl_add_u32 v13, v15, 5, v8
    s_mul_i32 s32, s30, 7168
    s_add_u32 s32, s32, 16384
    v_add_u32 v14, s32, v3
    v_bfe_u32 v15, v1, 2, 2
    s_and_b32 s32, s17, 2
    v_lshl_add_u32 v15, s32, 2, v15
    v_cmp_eq_u32 s[52:53], v253, v15
    s_waitcnt vmcnt(12)
    v_add_u32 v7, 147456, v7
    v_add_u32 v9, 147456, v9
    ds_read_b64_tr_b16 a[0:1], v7 offset:0
    ds_read_b64_tr_b16 a[2:3], v7 offset:512
    ds_read_b64_tr_b16 a[4:5], v7 offset:8
    ds_read_b64_tr_b16 a[6:7], v7 offset:520
    ds_read_b64_tr_b16 a[8:9], v9 offset:0
    ds_read_b64_tr_b16 a[10:11], v9 offset:512
    ds_read_b64_tr_b16 a[12:13], v9 offset:8
    ds_read_b64_tr_b16 a[14:15], v9 offset:520
    v_add_u32 v7, 4294909952, v7
    v_add_u32 v9, 4294909952, v9
    ds_read_b64_tr_b16 a[16:17], v7 offset:0
    ds_read_b64_tr_b16 a[18:19], v7 offset:512
    ds_read_b64_tr_b16 a[20:21], v7 offset:8
    ds_read_b64_tr_b16 a[22:23], v7 offset:520
    ds_read_b64_tr_b16 a[24:25], v9 offset:0
    ds_read_b64_tr_b16 a[26:27], v9 offset:512
    ds_read_b64_tr_b16 a[28:29], v9 offset:8
    ds_read_b64_tr_b16 a[30:31], v9 offset:520
    ds_read_b64_tr_b16 a[32:33], v7 offset:16384
    ds_read_b64_tr_b16 a[34:35], v7 offset:16896
    ds_read_b64_tr_b16 a[36:37], v7 offset:16392
    ds_read_b64_tr_b16 a[38:39], v7 offset:16904
    ds_read_b64_tr_b16 a[40:41], v9 offset:16384
    ds_read_b64_tr_b16 a[42:43], v9 offset:16896
    ds_read_b64_tr_b16 a[44:45], v9 offset:16392
    ds_read_b64_tr_b16 a[46:47], v9 offset:16904
    s_and_b32 s0, s2, 7
    s_lshl_b32 s0, s0, 7
    s_add_u32 s0, s0, 4277248
    v_mov_b32 v16, s0
    v_mov_b32 v17, 1
    s_cmp_lg_u32 s22, 0
    s_waitcnt vmcnt(8)
    s_barrier
    s_cbranch_scc1 L_arr2
    s_mov_b64 exec, 1
    global_atomic_add v18, v16, v17, s[4:5] sc0 sc1
    s_mov_b64 exec, -1
L_arr2:
    v_mov_b32 v232, 0x3f803f80
    v_mov_b32 v233, 0x3f803f80
    v_mov_b32 v234, 0x3f803f80
    v_mov_b32 v235, 0x3f803f80
    s_waitcnt lgkmcnt(0)
    s_lshl_b32 s25, s16, 3
    s_add_u32 m0, s24, 147456
    s_add_u32 s25, s25, s31
    s_lshl_b32 s25, s25, 10
    s_lshl_b32 s32, s33, 6
    s_mul_i32 s44, s61, 44
    s_add_u32 s32, s32, s25
    s_add_u32 s32, s32, 4325376
    v_lshlrev_b32 v15, 3, v252
    v_add_u32 v254, s32, v15
    buffer_load_dwordx4 v240, s[40:43], s44 offen offset:0 sc1 lds
    v_lshlrev_b32 v255, 10, v253
    v_xor_b32 v255, s25, v255
    v_add_u32 v255, v255, v15
    v_add_u32 v255, 4325376, v255
    s_mul_i32 s44, s61, 48
    s_andn2_b32 s34, 1, s2
    s_lshl_b32 s34, s34, 3
    s_and_b32 s35, s2, 6
    s_add_u32 s34, s34, s35
    buffer_load_dwordx4 v241, s[40:43], s44 offen offset:1024 sc1 lds
    s_lshl_b32 s34, s34, 1
    s_bfe_u32 s35, s2, 0x20003
    s_add_u32 s34, s34, s35
    buffer_load_dwordx4 v242, s[40:43], s44 offen offset:2048 sc1 lds
    s_lshr_b32 s35, s2, 5
    s_mul_i32 s25, s34, 458752
    s_add_u32 s25, s25, 18874368
    s_add_u32 s36, s4, s25
    s_addc_u32 s37, s5, 0
    buffer_load_dwordx4 v243, s[40:43], s44 offen offset:3072 sc1 lds
    s_mov_b32 s38, 458752
    s_mov_b32 s39, 0x20000
    s_mul_i32 s45, s22, 114688
    s_mul_i32 s57, s17, 14
    s_add_u32 m0, s24, 90112
    s_mul_i32 s32, s30, 7
    s_add_u32 s57, s57, s32
    s_lshl_b32 s54, s16, 1
    s_lshr_b32 s25, s22, 1
    s_mul_i32 s44, s61, 3
    s_add_u32 s54, s54, s25
    s_lshr_b32 s25, s17, 2
    s_lshl2_add_u32 s58, s54, s25
    s_mul_i32 s58, s58, 56
    buffer_load_dwordx4 v240, s[40:43], s44 offen offset:0 sc1 lds
    s_and_b32 s25, s17, 3
    s_lshl1_add_u32 s25, s25, s30
    s_mul_i32 s63, s25, 3
    buffer_load_dwordx4 v241, s[40:43], s44 offen offset:1024 sc1 lds
    s_add_u32 s58, s58, s63
    s_lshl_b32 s58, s58, 11
    s_add_u32 s58, s58, 18878464
    s_mul_i32 s63, s25, 2048
    buffer_load_dwordx4 v242, s[40:43], s44 offen offset:2048 sc1 lds
    s_add_u32 s63, s63, 49152
    s_lshl_b32 s57, s57, 11
    s_add_u32 s57, s57, 4722688
    s_and_b32 s59, s31, 3
    buffer_load_dwordx4 v243, s[40:43], s44 offen offset:3072 sc1 lds
    s_lshl_b32 s59, s59, 9
    s_lshl_b32 s54, s54, 2
    s_lshr_b32 s32, s17, 2
    s_add_u32 s54, s54, s32
    s_add_u32 m0, s24, 106496
    s_lshl_b32 s54, s54, 8
    s_add_u32 s54, s54, 4456448
    v_lshrrev_b32 v236, 3, v1
    v_lshl_add_u32 v236, v2, 4, v236
    s_mul_i32 s44, s61, 10
    v_lshlrev_b32 v236, 9, v236
    v_lshrrev_b32 v237, 5, v1
    s_and_b32 s25, s34, 1
    buffer_load_dwordx4 v240, s[40:43], s44 offen offset:0 sc1 lds
    v_xor_b32 v237, s25, v237
    v_lshl_add_u32 v236, v237, 7, v236
    v_and_b32 v237, 7, v1
    v_lshl_add_u32 v236, v237, 4, v236
    buffer_load_dwordx4 v241, s[40:43], s44 offen offset:1024 sc1 lds
    s_lshr_b32 s25, s34, 1
    s_lshl_b32 s25, s25, 18
    s_lshl_b32 s32, s35, 15
    s_add_u32 s25, s25, s32
    buffer_load_dwordx4 v242, s[40:43], s44 offen offset:2048 sc1 lds
    s_add_u32 s25, s25, 6291456
    v_add_u32 v236, s25, v236
    v_add_u32 v237, 4096, v236
    v_lshlrev_b32 v8, 4, v252
    buffer_load_dwordx4 v243, s[40:43], s44 offen offset:3072 sc1 lds
    v_lshl_add_u32 v8, v253, 11, v8
    v_add_u32 v15, s57, v4
    v_add_u32 v239, 8192, v15
    s_cmp_lg_u32 s22, 0
    s_waitcnt vmcnt(12)
    s_cbranch_scc1 L_a2_done
    v_lshlrev_b32 v16, 7, v1
    v_add_u32 v16, 4268032, v16
    s_waitcnt vmcnt(12)
    v_readfirstlane_b32 s0, v18
    s_nop 0
    s_cmp_lg_u32 s0, 31
    s_cbranch_scc1 L_a2_done
    s_mov_b64 exec, -1
    global_atomic_add v16, v17, s[4:5] sc1
    s_mov_b64 exec, -1
L_a2_done:
    v_add_u32 v7, 4294934528, v7
    s_add_u32 m0, s24, 122880
    v_add_u32 v9, 4294934528, v9
    ds_read_b64_tr_b16 a[48:49], v7 offset:0
    ds_read_b64_tr_b16 a[50:51], v7 offset:512
    s_mul_i32 s44, s61, 17
    ds_read_b64_tr_b16 a[52:53], v7 offset:8
    ds_read_b64_tr_b16 a[54:55], v7 offset:520
    ds_read_b64_tr_b16 a[56:57], v9 offset:0
    buffer_load_dwordx4 v240, s[40:43], s44 offen offset:0 sc1 lds
    ds_read_b64_tr_b16 a[58:59], v9 offset:512
    ds_read_b64_tr_b16 a[60:61], v9 offset:8
    ds_read_b64_tr_b16 a[62:63], v9 offset:520
    buffer_load_dwordx4 v241, s[40:43], s44 offen offset:1024 sc1 lds
    ds_read_b64_tr_b16 a[64:65], v7 offset:16384
    ds_read_b64_tr_b16 a[66:67], v7 offset:16896
    ds_read_b64_tr_b16 a[68:69], v7 offset:16392
    buffer_load_dwordx4 v242, s[40:43], s44 offen offset:2048 sc1 lds
    ds_read_b64_tr_b16 a[70:71], v7 offset:16904
    ds_read_b64_tr_b16 a[72:73], v9 offset:16384
    ds_read_b64_tr_b16 a[74:75], v9 offset:16896
    buffer_load_dwordx4 v243, s[40:43], s44 offen offset:3072 sc1 lds
    ds_read_b64_tr_b16 a[76:77], v9 offset:16392
    ds_read_b64_tr_b16 a[78:79], v9 offset:16904
    s_waitcnt lgkmcnt(0)
    s_and_b32 s0, s2, 63
    s_lshl_b32 s0, s0, 7
    s_add_u32 s0, s0, 4268032
    s_cmp_lg_u32 s22, 0
    s_cbranch_scc1 L_f2_p
    s_load_dword s1, s[4:5], s0 glc
L_f2_p:
    s_add_u32 m0, s24, 57344
    s_mul_i32 s44, s61, 24
    buffer_load_dwordx4 v240, s[40:43], s44 offen offset:0 sc1 lds
    buffer_load_dwordx4 v241, s[40:43], s44 offen offset:1024 sc1 lds
    buffer_load_dwordx4 v242, s[40:43], s44 offen offset:2048 sc1 lds
    buffer_load_dwordx4 v243, s[40:43], s44 offen offset:3072 sc1 lds
    s_add_u32 m0, s24, 73728
    s_mul_i32 s44, s61, 31
    buffer_load_dwordx4 v240, s[40:43], s44 offen offset:0 sc1 lds
    buffer_load_dwordx4 v241, s[40:43], s44 offen offset:1024 sc1 lds
    buffer_load_dwordx4 v242, s[40:43], s44 offen offset:2048 sc1 lds
    buffer_load_dwordx4 v243, s[40:43], s44 offen offset:3072 sc1 lds
    s_cmp_lg_u32 s22, 0
    s_cbranch_scc1 L_f2_go
    s_mov_b32 s3, 0
    s_branch L_f2_t
L_f2:
    s_load_dword s1, s[4:5], s0 glc
L_f2_t:
    s_add_u32 s3, s3, 1
    s_cmp_gt_u32 s3, 400000
    s_waitcnt lgkmcnt(0)
    s_cbranch_scc1 L_f2_x
    s_cmp_lg_u32 s1, 8
    s_cbranch_scc1 L_f2
L_f2_x:
L_f2_go:
    s_mov_b64 exec, 0
    s_cmp_eq_u32 s22, 1
    s_cbranch_scc1 T_f2_1_0
    s_cmp_eq_u32 s22, 2
    s_cbranch_scc1 T_f2_2_0
    s_cmp_eq_u32 s22, 3
    s_cbranch_scc1 T_f2_3_0
T_f2_back:
    s_mov_b64 exec, -1
    s_waitcnt lgkmcnt(0)
    s_barrier
    s_lshl_b32 s26, s28, 15
    s_add_u32 m0, s23, 0
    s_mul_i32 s27, s28, 57344
    buffer_load_dwordx4 v4, s[8:11], s26 offen offset:0 sc1  lds
    buffer_load_dwordx4 v5, s[8:11], s26 offen offset:1024 sc1  lds
    s_add_u32 m0, s24, 16384
    s_add_u32 s26, s26, 16384
    buffer_load_dwordx4 v4, s[12:15], s27 offen offset:0 sc1  lds
    buffer_load_dwordx4 v5, s[12:15], s27 offen offset:1024 sc1  lds
    buffer_load_dwordx4 v6, s[12:15], s27 offen offset:2048 sc1  lds
    buffer_load_dwordx4 v238, s[12:15], s27 offen offset:3072 sc1  lds
    s_barrier
    s_waitcnt vmcnt(6)
    ds_read_b64_tr_b16 a[144:145], v7 offset:0
    s_add_u32 m0, s23, 8192
    ds_read_b64_tr_b16 a[146:147], v7 offset:512
    s_add_u32 s28, s28, 1
    ds_read_b64_tr_b16 a[148:149], v7 offset:8
    ds_read_b64_tr_b16 a[150:151], v7 offset:520
    buffer_load_dwordx4 v4, s[8:11], s26 offen offset:0 sc1  lds
    ds_read_b64_tr_b16 a[152:153], v9 offset:0
    buffer_load_dwordx4 v5, s[8:11], s26 offen offset:1024 sc1  lds
    ds_read_b64_tr_b16 a[154:155], v9 offset:512
    ds_read_b64_tr_b16 a[156:157], v9 offset:8
    s_add_u32 s27, s27, s56
    ds_read_b64_tr_b16 a[158:159], v9 offset:520
    ds_read_b64_tr_b16 a[160:161], v7 offset:16384
    s_add_u32 m0, s29, 16384
    ds_read_b64_tr_b16 a[162:163], v7 offset:16896
    s_and_b32 s28, s28, 7
    ds_read_b64_tr_b16 a[164:165], v7 offset:16392
    ds_read_b64_tr_b16 a[166:167], v7 offset:16904
    buffer_load_dwordx4 v4, s[12:15], s27 offen offset:0 sc1  lds
    ds_read_b64_tr_b16 a[168:169], v9 offset:16384
    buffer_load_dwordx4 v5, s[12:15], s27 offen offset:1024 sc1  lds
    ds_read_b64_tr_b16 a[170:171], v9 offset:16896
    ds_read_b64_tr_b16 a[172:173], v9 offset:16392
    buffer_load_dwordx4 v6, s[12:15], s27 offen offset:2048 sc1  lds
    ds_read_b64_tr_b16 a[174:175], v9 offset:16904
    s_waitcnt lgkmcnt(0)
    s_barrier
    s_lshl_b32 s26, s28, 15
    v_add_u32 v7, 90112, v7
    v_add_u32 v9, 90112, v9
    ds_read_b64_tr_b16 a[80:81], v7 offset:0
    ds_read_b64_tr_b16 a[82:83], v7 offset:512
    s_add_u32 m0, s23, 45056
    ds_read_b64_tr_b16 a[84:85], v7 offset:8
    ds_read_b64_tr_b16 a[86:87], v7 offset:520
    ds_read_b64_tr_b16 a[88:89], v9 offset:0
    s_mul_i32 s27, s28, 57344
    ds_read_b64_tr_b16 a[90:91], v9 offset:512
    ds_read_b64_tr_b16 a[92:93], v9 offset:8
    ds_read_b64_tr_b16 a[94:95], v9 offset:520
    buffer_load_dwordx4 v4, s[8:11], s26 offen offset:0 sc1  lds
    v_add_u32 v7, 4294909952, v7
    v_add_u32 v9, 4294909952, v9
    ds_read_b64_tr_b16 a[96:97], v7 offset:0
    ds_read_b64_tr_b16 a[98:99], v7 offset:512
    buffer_load_dwordx4 v5, s[8:11], s26 offen offset:1024 sc1  lds
    ds_read_b64_tr_b16 a[100:101], v7 offset:8
    ds_read_b64_tr_b16 a[102:103], v7 offset:520
    ds_read_b64_tr_b16 a[104:105], v9 offset:0
    s_add_u32 m0, s24, 61440
    ds_read_b64_tr_b16 a[106:107], v9 offset:512
    ds_read_b64_tr_b16 a[108:109], v9 offset:8
    ds_read_b64_tr_b16 a[110:111], v9 offset:520
    s_add_u32 s26, s26, 16384
    ds_read_b64_tr_b16 a[112:113], v7 offset:16384
    ds_read_b64_tr_b16 a[114:115], v7 offset:16896
    ds_read_b64_tr_b16 a[116:117], v7 offset:16392
    buffer_load_dwordx4 v4, s[12:15], s27 offen offset:0 sc1  lds
    ds_read_b64_tr_b16 a[118:119], v7 offset:16904
    ds_read_b64_tr_b16 a[120:121], v9 offset:16384
    ds_read_b64_tr_b16 a[122:123], v9 offset:16896
    ds_read_b64_tr_b16 a[124:125], v9 offset:16392
    buffer_load_dwordx4 v5, s[12:15], s27 offen offset:1024 sc1  lds
    ds_read_b64_tr_b16 a[126:127], v9 offset:16904
    ds_read_b64_tr_b16 a[128:129], v7 offset:32768
    ds_read_b64_tr_b16 a[130:131], v7 offset:33280
    buffer_load_dwordx4 v6, s[12:15], s27 offen offset:2048 sc1  lds
    ds_read_b64_tr_b16 a[132:133], v7 offset:32776
    ds_read_b64_tr_b16 a[134:135], v7 offset:33288
    ds_read_b64_tr_b16 a[136:137], v9 offset:32768
    buffer_load_dwordx4 v238, s[12:15], s27 offen offset:3072 sc1  lds
    ds_read_b64_tr_b16 a[138:139], v9 offset:33280
    ds_read_b64_tr_b16 a[140:141], v9 offset:32776
    ds_read_b64_tr_b16 a[142:143], v9 offset:33288
    s_waitcnt vmcnt(11) lgkmcnt(0)
    s_barrier
    ds_read_b128 v[160:163], v14 offset:0
    ds_read_b64_tr_b16 v[144:145], v10 offset:0
    ds_read_b64_tr_b16 v[146:147], v10 offset:4096
    ds_read_b64_tr_b16 v[148:149], v11 offset:0
    ds_read_b64_tr_b16 v[150:151], v11 offset:4096
    ds_read_b64_tr_b16 v[152:153], v12 offset:0
    ds_read_b64_tr_b16 v[154:155], v12 offset:4096
    ds_read_b64_tr_b16 v[156:157], v13 offset:0
    ds_read_b64_tr_b16 v[158:159], v13 offset:4096
    ds_read_b128 v[164:167], v14 offset:1024
    ds_read_b128 v[168:171], v14 offset:2048
    ds_read_b128 v[172:175], v14 offset:3072
    ds_read_b128 v[176:179], v14 offset:4096
    ds_read_b128 v[180:183], v14 offset:5120
    ds_read_b128 v[184:187], v14 offset:6144
    s_add_u32 m0, s23, 53248
    s_add_u32 s28, s28, 1
    buffer_load_dwordx4 v4, s[8:11], s26 offen offset:0 sc1  lds
    buffer_load_dwordx4 v5, s[8:11], s26 offen offset:1024 sc1  lds
    s_waitcnt lgkmcnt(0)
    v_mfma_f32_16x16x32_bf16 v[16:19], v[160:163], v[144:147], 0
    v_mfma_f32_16x16x32_bf16 v[20:23], v[160:163], v[148:151], 0
    s_add_u32 s27, s27, s56
    v_mfma_f32_16x16x32_bf16 v[24:27], v[160:163], v[152:155], 0
    s_add_u32 m0, s29, 61440
    v_mfma_f32_16x16x32_bf16 v[28:31], v[160:163], v[156:159], 0
    s_and_b32 s28, s28, 7
    v_mfma_f32_16x16x32_bf16 v[44:47], v[164:167], v[156:159], 0
    buffer_load_dwordx4 v4, s[12:15], s27 offen offset:0 sc1  lds
    v_mfma_f32_16x16x32_bf16 v[40:43], v[164:167], v[152:155], 0
    v_mfma_f32_16x16x32_bf16 v[36:39], v[164:167], v[148:151], 0
    v_mfma_f32_16x16x32_bf16 v[32:35], v[164:167], v[144:147], 0
    s_waitcnt vmcnt(9)
    s_barrier
    v_mfma_f32_16x16x32_bf16 v[128:131], v[144:147], v[144:147], 0
    ds_read_b128 v[204:207], v14 offset:14336
    v_mfma_f32_16x16x32_bf16 v[132:135], v[232:235], v[144:147], 0
    ds_read_b64_tr_b16 v[188:189], v10 offset:8192
    buffer_load_dwordx4 v5, s[12:15], s27 offen offset:1024 sc1  lds
    v_mfma_f32_16x16x32_bf16 v[48:51], v[168:171], v[144:147], 0
    ds_read_b64_tr_b16 v[190:191], v10 offset:12288
    v_mfma_f32_16x16x32_bf16 v[52:55], v[168:171], v[148:151], 0
    ds_read_b64_tr_b16 v[192:193], v11 offset:8192
    v_mfma_f32_16x16x32_bf16 v[56:59], v[168:171], v[152:155], 0
    ds_read_b64_tr_b16 v[194:195], v11 offset:12288
    v_mfma_f32_16x16x32_bf16 v[60:63], v[168:171], v[156:159], 0
    ds_read_b64_tr_b16 v[196:197], v12 offset:8192
    buffer_load_dwordx4 v6, s[12:15], s27 offen offset:2048 sc1  lds
    v_mfma_f32_16x16x32_bf16 v[76:79], v[172:175], v[156:159], 0
    ds_read_b64_tr_b16 v[198:199], v12 offset:12288
    s_lshl_b32 s26, s28, 15
    v_mfma_f32_16x16x32_bf16 v[72:75], v[172:175], v[152:155], 0
    ds_read_b64_tr_b16 v[200:201], v13 offset:8192
    s_add_u32 m0, s23, 90112
    v_mfma_f32_16x16x32_bf16 v[68:71], v[172:175], v[148:151], 0
    ds_read_b64_tr_b16 v[202:203], v13 offset:12288
    s_mul_i32 s27, s28, 57344
    v_mfma_f32_16x16x32_bf16 v[64:67], v[172:175], v[144:147], 0
    ds_read_b128 v[208:211], v14 offset:15360
    buffer_load_dwordx4 v4, s[8:11], s26 offen offset:0 sc1  lds
    v_mfma_f32_16x16x32_bf16 v[80:83], v[176:179], v[144:147], 0
    ds_read_b128 v[212:215], v14 offset:16384
    v_mfma_f32_16x16x32_bf16 v[84:87], v[176:179], v[148:151], 0
    ds_read_b128 v[216:219], v14 offset:17408
    v_mfma_f32_16x16x32_bf16 v[88:91], v[176:179], v[152:155], 0
    ds_read_b128 v[220:223], v14 offset:18432
    buffer_load_dwordx4 v5, s[8:11], s26 offen offset:1024 sc1  lds
    v_mfma_f32_16x16x32_bf16 v[92:95], v[176:179], v[156:159], 0
    ds_read_b128 v[224:227], v14 offset:19456
    v_mfma_f32_16x16x32_bf16 v[108:111], v[180:183], v[156:159], 0
    ds_read_b128 v[228:231], v14 offset:20480
    s_add_u32 m0, s24, 106496
    v_mfma_f32_16x16x32_bf16 v[104:107], v[180:183], v[152:155], 0
    v_add_u32 v10, 45056, v10
    s_add_u32 s26, s26, 16384
    v_mfma_f32_16x16x32_bf16 v[100:103], v[180:183], v[148:151], 0
    v_add_u32 v11, 45056, v11
    buffer_load_dwordx4 v4, s[12:15], s27 offen offset:0 sc1  lds
    v_mfma_f32_16x16x32_bf16 v[96:99], v[180:183], v[144:147], 0
    v_add_u32 v12, 45056, v12
    v_mfma_f32_16x16x32_bf16 v[112:115], v[184:187], v[144:147], 0
    v_add_u32 v13, 45056, v13
    v_mfma_f32_16x16x32_bf16 v[116:119], v[184:187], v[148:151], 0
    v_add_u32 v14, 45056, v14
    v_mfma_f32_16x16x32_bf16 v[120:123], v[184:187], v[152:155], 0
    buffer_load_dwordx4 v5, s[12:15], s27 offen offset:1024 sc1  lds
    v_mfma_f32_16x16x32_bf16 v[124:127], v[184:187], v[156:159], 0
    s_waitcnt lgkmcnt(0)
    v_mfma_f32_16x16x32_bf16 v[16:19], v[204:207], v[188:191], v[16:19]
    v_mfma_f32_16x16x32_bf16 v[20:23], v[204:207], v[192:195], v[20:23]
    v_mfma_f32_16x16x32_bf16 v[24:27], v[204:207], v[196:199], v[24:27]
    v_mfma_f32_16x16x32_bf16 v[28:31], v[204:207], v[200:203], v[28:31]
    v_mfma_f32_16x16x32_bf16 v[44:47], v[208:211], v[200:203], v[44:47]
    buffer_load_dwordx4 v6, s[12:15], s27 offen offset:2048 sc1  lds
    v_mfma_f32_16x16x32_bf16 v[40:43], v[208:211], v[196:199], v[40:43]
    v_mfma_f32_16x16x32_bf16 v[36:39], v[208:211], v[192:195], v[36:39]
    v_mfma_f32_16x16x32_bf16 v[32:35], v[208:211], v[188:191], v[32:35]
    s_waitcnt vmcnt(10)
    s_barrier
    v_mfma_f32_16x16x32_bf16 v[128:131], v[188:191], v[188:191], v[128:131]
    ds_read_b128 v[160:163], v14 offset:0
    v_mfma_f32_16x16x32_bf16 v[132:135], v[232:235], v[188:191], v[132:135]
    ds_read_b64_tr_b16 v[144:145], v10 offset:0
    buffer_load_dwordx4 v238, s[12:15], s27 offen offset:3072 sc1  lds
    v_mfma_f32_16x16x32_bf16 v[48:51], v[212:215], v[188:191], v[48:51]
    ds_read_b64_tr_b16 v[146:147], v10 offset:4096
    v_mfma_f32_16x16x32_bf16 v[52:55], v[212:215], v[192:195], v[52:55]
    ds_read_b64_tr_b16 v[148:149], v11 offset:0
    s_add_u32 m0, s23, 98304
    v_mfma_f32_16x16x32_bf16 v[56:59], v[212:215], v[196:199], v[56:59]
    ds_read_b64_tr_b16 v[150:151], v11 offset:4096
    s_add_u32 s28, s28, 1
    v_mfma_f32_16x16x32_bf16 v[60:63], v[212:215], v[200:203], v[60:63]
    ds_read_b64_tr_b16 v[152:153], v12 offset:0
    buffer_load_dwordx4 v4, s[8:11], s26 offen offset:0 sc1  lds
    v_mfma_f32_16x16x32_bf16 v[76:79], v[216:219], v[200:203], v[76:79]
    ds_read_b64_tr_b16 v[154:155], v12 offset:4096
    v_mfma_f32_16x16x32_bf16 v[72:75], v[216:219], v[196:199], v[72:75]
    ds_read_b64_tr_b16 v[156:157], v13 offset:0
    v_mfma_f32_16x16x32_bf16 v[68:71], v[216:219], v[192:195], v[68:71]
    ds_read_b64_tr_b16 v[158:159], v13 offset:4096
    v_mfma_f32_16x16x32_bf16 v[64:67], v[216:219], v[188:191], v[64:67]
    ds_read_b128 v[164:167], v14 offset:1024
    buffer_load_dwordx4 v5, s[8:11], s26 offen offset:1024 sc1  lds
    s_add_u32 s27, s27, s56
    v_mfma_f32_16x16x32_bf16 v[80:83], v[220:223], v[188:191], v[80:83]
    ds_read_b128 v[168:171], v14 offset:2048
    s_add_u32 m0, s29, 106496
    v_mfma_f32_16x16x32_bf16 v[84:87], v[220:223], v[192:195], v[84:87]
    ds_read_b128 v[172:175], v14 offset:3072
    s_and_b32 s28, s28, 7
    v_mfma_f32_16x16x32_bf16 v[88:91], v[220:223], v[196:199], v[88:91]
    ds_read_b128 v[176:179], v14 offset:4096
    buffer_load_dwordx4 v4, s[12:15], s27 offen offset:0 sc1  lds
    v_mfma_f32_16x16x32_bf16 v[92:95], v[220:223], v[200:203], v[92:95]
    ds_read_b128 v[180:183], v14 offset:5120
    v_mfma_f32_16x16x32_bf16 v[108:111], v[224:227], v[200:203], v[108:111]
    ds_read_b128 v[184:187], v14 offset:6144
    v_mfma_f32_16x16x32_bf16 v[104:107], v[224:227], v[196:199], v[104:107]
    v_mfma_f32_16x16x32_bf16 v[100:103], v[224:227], v[192:195], v[100:103]
    buffer_load_dwordx4 v5, s[12:15], s27 offen offset:1024 sc1  lds
    v_mfma_f32_16x16x32_bf16 v[96:99], v[224:227], v[188:191], v[96:99]
    v_mfma_f32_16x16x32_bf16 v[112:115], v[228:231], v[188:191], v[112:115]
    v_mfma_f32_16x16x32_bf16 v[116:119], v[228:231], v[192:195], v[116:119]
    v_mfma_f32_16x16x32_bf16 v[120:123], v[228:231], v[196:199], v[120:123]
    buffer_load_dwordx4 v6, s[12:15], s27 offen offset:2048 sc1  lds
    v_mfma_f32_16x16x32_bf16 v[124:127], v[228:231], v[200:203], v[124:127]
    s_waitcnt lgkmcnt(0)
    v_mfma_f32_16x16x32_bf16 v[16:19], v[160:163], v[144:147], v[16:19]
    v_mfma_f32_16x16x32_bf16 v[20:23], v[160:163], v[148:151], v[20:23]
    s_lshl_b32 s26, s28, 15
    v_mfma_f32_16x16x32_bf16 v[24:27], v[160:163], v[152:155], v[24:27]
    s_add_u32 m0, s23, 0
    v_mfma_f32_16x16x32_bf16 v[28:31], v[160:163], v[156:159], v[28:31]
    s_mul_i32 s27, s28, 57344
    v_mfma_f32_16x16x32_bf16 v[44:47], v[164:167], v[156:159], v[44:47]
    buffer_load_dwordx4 v4, s[8:11], s26 offen offset:0 sc1  lds
    v_mfma_f32_16x16x32_bf16 v[40:43], v[164:167], v[152:155], v[40:43]
    v_mfma_f32_16x16x32_bf16 v[36:39], v[164:167], v[148:151], v[36:39]
    v_mfma_f32_16x16x32_bf16 v[32:35], v[164:167], v[144:147], v[32:35]
    s_waitcnt vmcnt(12)
    s_barrier
    v_mfma_f32_16x16x32_bf16 v[128:131], v[144:147], v[144:147], v[128:131]
    ds_read_b128 v[204:207], v14 offset:14336
    v_mfma_f32_16x16x32_bf16 v[132:135], v[232:235], v[144:147], v[132:135]
    ds_read_b64_tr_b16 v[188:189], v10 offset:8192
    buffer_load_dwordx4 v5, s[8:11], s26 offen offset:1024 sc1  lds
    v_mfma_f32_16x16x32_bf16 v[48:51], v[168:171], v[144:147], v[48:51]
    ds_read_b64_tr_b16 v[190:191], v10 offset:12288
    v_mfma_f32_16x16x32_bf16 v[52:55], v[168:171], v[148:151], v[52:55]
    ds_read_b64_tr_b16 v[192:193], v11 offset:8192
    s_add_u32 m0, s24, 16384
    v_mfma_f32_16x16x32_bf16 v[56:59], v[168:171], v[152:155], v[56:59]
    ds_read_b64_tr_b16 v[194:195], v11 offset:12288
    s_add_u32 s26, s26, 16384
    v_mfma_f32_16x16x32_bf16 v[60:63], v[168:171], v[156:159], v[60:63]
    ds_read_b64_tr_b16 v[196:197], v12 offset:8192
    buffer_load_dwordx4 v4, s[12:15], s27 offen offset:0 sc1  lds
    v_mfma_f32_16x16x32_bf16 v[76:79], v[172:175], v[156:159], v[76:79]
    ds_read_b64_tr_b16 v[198:199], v12 offset:12288
    v_mfma_f32_16x16x32_bf16 v[72:75], v[172:175], v[152:155], v[72:75]
    ds_read_b64_tr_b16 v[200:201], v13 offset:8192
    v_mfma_f32_16x16x32_bf16 v[68:71], v[172:175], v[148:151], v[68:71]
T_f2_2_0:
    s_cbranch_execz T_f2_2_1
    ds_read_b64_tr_b16 v[202:203], v13 offset:12288
    v_mfma_f32_16x16x32_bf16 v[64:67], v[172:175], v[144:147], v[64:67]
    ds_read_b128 v[208:211], v14 offset:15360
    buffer_load_dwordx4 v5, s[12:15], s27 offen offset:1024 sc1  lds
    v_mfma_f32_16x16x32_bf16 v[80:83], v[176:179], v[144:147], v[80:83]
    ds_read_b128 v[212:215], v14 offset:16384
    v_mfma_f32_16x16x32_bf16 v[84:87], v[176:179], v[148:151], v[84:87]
    ds_read_b128 v[216:219], v14 offset:17408
    v_mfma_f32_16x16x32_bf16 v[88:91], v[176:179], v[152:155], v[88:91]
    ds_read_b128 v[220:223], v14 offset:18432
    buffer_load_dwordx4 v6, s[12:15], s27 offen offset:2048 sc1  lds
    v_mfma_f32_16x16x32_bf16 v[92:95], v[176:179], v[156:159], v[92:95]
    ds_read_b128 v[224:227], v14 offset:19456
    v_mfma_f32_16x16x32_bf16 v[108:111], v[180:183], v[156:159], v[108:111]
    ds_read_b128 v[228:231], v14 offset:20480
    v_mfma_f32_16x16x32_bf16 v[104:107], v[180:183], v[152:155], v[104:107]
    v_add_u32 v10, 45056, v10
    v_mfma_f32_16x16x32_bf16 v[100:103], v[180:183], v[148:151], v[100:103]
    v_add_u32 v11, 45056, v11
    buffer_load_dwordx4 v238, s[12:15], s27 offen offset:3072 sc1  lds
    v_mfma_f32_16x16x32_bf16 v[96:99], v[180:183], v[144:147], v[96:99]
    v_add_u32 v12, 45056, v12
    v_mfma_f32_16x16x32_bf16 v[112:115], v[184:187], v[144:147], v[112:115]
    v_add_u32 v13, 45056, v13
T_f2_2_1:
    s_cbranch_execz T_f2_back
    s_add_u32 m0, s23, 8192
    v_mfma_f32_16x16x32_bf16 v[116:119], v[184:187], v[148:151], v[116:119]
    v_add_u32 v14, 45056, v14
    s_add_u32 s28, s28, 1
    v_mfma_f32_16x16x32_bf16 v[120:123], v[184:187], v[152:155], v[120:123]
    buffer_load_dwordx4 v4, s[8:11], s26 offen offset:0 sc1  lds
    v_mfma_f32_16x16x32_bf16 v[124:127], v[184:187], v[156:159], v[124:127]
    s_waitcnt lgkmcnt(0)
    v_mfma_f32_16x16x32_bf16 v[16:19], v[204:207], v[188:191], v[16:19]
    v_mfma_f32_16x16x32_bf16 v[20:23], v[204:207], v[192:195], v[20:23]
    v_mfma_f32_16x16x32_bf16 v[24:27], v[204:207], v[196:199], v[24:27]
    v_mfma_f32_16x16x32_bf16 v[28:31], v[204:207], v[200:203], v[28:31]
    v_mfma_f32_16x16x32_bf16 v[44:47], v[208:211], v[200:203], v[44:47]
    buffer_load_dwordx4 v5, s[8:11], s26 offen offset:1024 sc1  lds
    v_mfma_f32_16x16x32_bf16 v[40:43], v[208:211], v[196:199], v[40:43]
    v_mfma_f32_16x16x32_bf16 v[36:39], v[208:211], v[192:195], v[36:39]
    v_mfma_f32_16x16x32_bf16 v[32:35], v[208:211], v[188:191], v[32:35]
    s_waitcnt vmcnt(8)
    s_barrier
    v_mfma_f32_16x16x32_bf16 v[128:131], v[188:191], v[188:191], v[128:131]
    ds_read_b128 v[160:163], v14 offset:0
    s_add_u32 s27, s27, s56
    s_add_u32 m0, s29, 16384
    s_and_b32 s28, s28, 7
    v_mfma_f32_16x16x32_bf16 v[132:135], v[232:235], v[188:191], v[132:135]
    ds_read_b64_tr_b16 v[144:145], v10 offset:0
    buffer_load_dwordx4 v4, s[12:15], s27 offen offset:0 sc1  lds
    v_mfma_f32_16x16x32_bf16 v[48:51], v[212:215], v[188:191], v[48:51]
    ds_read_b64_tr_b16 v[146:147], v10 offset:4096
    v_mfma_f32_16x16x32_bf16 v[52:55], v[212:215], v[192:195], v[52:55]
    ds_read_b64_tr_b16 v[148:149], v11 offset:0
    v_mfma_f32_16x16x32_bf16 v[56:59], v[212:215], v[196:199], v[56:59]
    ds_read_b64_tr_b16 v[150:151], v11 offset:4096
    v_mfma_f32_16x16x32_bf16 v[60:63], v[212:215], v[200:203], v[60:63]
    ds_read_b64_tr_b16 v[152:153], v12 offset:0
    buffer_load_dwordx4 v5, s[12:15], s27 offen offset:1024 sc1  lds
    v_mfma_f32_16x16x32_bf16 v[76:79], v[216:219], v[200:203], v[76:79]
    ds_read_b64_tr_b16 v[154:155], v12 offset:4096
    v_mfma_f32_16x16x32_bf16 v[72:75], v[216:219], v[196:199], v[72:75]
    ds_read_b64_tr_b16 v[156:157], v13 offset:0
    v_mfma_f32_16x16x32_bf16 v[68:71], v[216:219], v[192:195], v[68:71]
    ds_read_b64_tr_b16 v[158:159], v13 offset:4096
    v_mfma_f32_16x16x32_bf16 v[64:67], v[216:219], v[188:191], v[64:67]
    ds_read_b128 v[164:167], v14 offset:1024
    buffer_load_dwordx4 v6, s[12:15], s27 offen offset:2048 sc1  lds
    v_mfma_f32_16x16x32_bf16 v[80:83], v[220:223], v[188:191], v[80:83]
    ds_read_b128 v[168:171], v14 offset:2048
    v_mfma_f32_16x16x32_bf16 v[84:87], v[220:223], v[192:195], v[84:87]
    ds_read_b128 v[172:175], v14 offset:3072
    s_add_u32 m0, s23, 139264
    v_mfma_f32_16x16x32_bf16 v[88:91], v[220:223], v[196:199], v[88:91]
    ds_read_b128 v[176:179], v14 offset:4096
    global_load_lds_dwordx4 v236, s[4:5] sc1
    v_mfma_f32_16x16x32_bf16 v[92:95], v[220:223], v[200:203], v[92:95]
    ds_read_b128 v[180:183], v14 offset:5120
    v_mfma_f32_16x16x32_bf16 v[108:111], v[224:227], v[200:203], v[108:111]
    ds_read_b128 v[184:187], v14 offset:6144
    v_mfma_f32_16x16x32_bf16 v[104:107], v[224:227], v[196:199], v[104:107]
    s_add_u32 m0, s23, 140288
    v_mfma_f32_16x16x32_bf16 v[100:103], v[224:227], v[192:195], v[100:103]
    global_load_lds_dwordx4 v237, s[4:5] sc1
    v_mfma_f32_16x16x32_bf16 v[96:99], v[224:227], v[188:191], v[96:99]
    s_lshl_b32 s26, s28, 15
    v_mfma_f32_16x16x32_bf16 v[112:115], v[228:231], v[188:191], v[112:115]
    s_add_u32 m0, s23, 45056
    v_mfma_f32_16x16x32_bf16 v[116:119], v[228:231], v[192:195], v[116:119]
    s_mul_i32 s27, s28, 57344
    v_mfma_f32_16x16x32_bf16 v[120:123], v[228:231], v[196:199], v[120:123]
    buffer_load_dwordx4 v4, s[8:11], s26 offen offset:0 sc1  lds
    v_mfma_f32_16x16x32_bf16 v[124:127], v[228:231], v[200:203], v[124:127]
    s_waitcnt lgkmcnt(0)
    v_mfma_f32_16x16x32_bf16 v[16:19], v[160:163], v[144:147], v[16:19]
    ds_read_b128 v[204:207], v14 offset:14336
    v_mfma_f32_16x16x32_bf16 v[20:23], v[160:163], v[148:151], v[20:23]
    ds_read_b64_tr_b16 v[188:189], v10 offset:8192
    v_cndmask_b32 v128, v128, v129, s[46:47]
    v_mfma_f32_16x16x32_bf16 v[24:27], v[160:163], v[152:155], v[24:27]
    ds_read_b64_tr_b16 v[190:191], v10 offset:12288
    buffer_load_dwordx4 v5, s[8:11], s26 offen offset:1024 sc1  lds
    v_mfma_f32_16x16x32_bf16 v[28:31], v[160:163], v[156:159], v[28:31]
    ds_read_b64_tr_b16 v[192:193], v11 offset:8192
    v_mfma_f32_16x16x32_bf16 v[44:47], v[164:167], v[156:159], v[44:47]
    ds_read_b64_tr_b16 v[194:195], v11 offset:12288
    v_mfma_f32_16x16x32_bf16 v[40:43], v[164:167], v[152:155], v[40:43]
    ds_read_b64_tr_b16 v[196:197], v12 offset:8192
    s_add_u32 m0, s24, 61440
    v_mfma_f32_16x16x32_bf16 v[36:39], v[164:167], v[148:151], v[36:39]
    ds_read_b64_tr_b16 v[198:199], v12 offset:12288
    s_add_u32 s26, s26, 16384
    v_mfma_f32_16x16x32_bf16 v[32:35], v[164:167], v[144:147], v[32:35]
    ds_read_b64_tr_b16 v[200:201], v13 offset:8192
    buffer_load_dwordx4 v4, s[12:15], s27 offen offset:0 sc1  lds
    v_mfma_f32_16x16x32_bf16 v[48:51], v[168:171], v[144:147], v[48:51]
    ds_read_b64_tr_b16 v[202:203], v13 offset:12288
    v_mfma_f32_16x16x32_bf16 v[52:55], v[168:171], v[148:151], v[52:55]
    ds_read_b128 v[208:211], v14 offset:15360
    v_mfma_f32_16x16x32_bf16 v[56:59], v[168:171], v[152:155], v[56:59]
    ds_read_b128 v[212:215], v14 offset:16384
    v_mfma_f32_16x16x32_bf16 v[60:63], v[168:171], v[156:159], v[60:63]
    ds_read_b128 v[216:219], v14 offset:17408
    buffer_load_dwordx4 v5, s[12:15], s27 offen offset:1024 sc1  lds
    v_mfma_f32_16x16x32_bf16 v[76:79], v[172:175], v[156:159], v[76:79]
    ds_read_b128 v[220:223], v14 offset:18432
    v_mfma_f32_16x16x32_bf16 v[72:75], v[172:175], v[152:155], v[72:75]
    ds_read_b128 v[224:227], v14 offset:19456
    v_mfma_f32_16x16x32_bf16 v[68:71], v[172:175], v[148:151], v[68:71]
    ds_read_b128 v[228:231], v14 offset:20480
    v_mfma_f32_16x16x32_bf16 v[64:67], v[172:175], v[144:147], v[64:67]
    v_add_u32 v10, 4294877184, v10
    v_mfma_f32_16x16x32_bf16 v[80:83], v[176:179], v[144:147], v[80:83]
    v_add_u32 v11, 4294877184, v11
    buffer_load_dwordx4 v6, s[12:15], s27 offen offset:2048 sc1  lds
    v_mfma_f32_16x16x32_bf16 v[84:87], v[176:179], v[148:151], v[84:87]
    v_add_u32 v12, 4294877184, v12
    v_mfma_f32_16x16x32_bf16 v[88:91], v[176:179], v[152:155], v[88:91]
    v_add_u32 v13, 4294877184, v13
    v_mfma_f32_16x16x32_bf16 v[92:95], v[176:179], v[156:159], v[92:95]
    v_add_u32 v14, 4294877184, v14
    v_mfma_f32_16x16x32_bf16 v[108:111], v[180:183], v[156:159], v[108:111]
    v_mfma_f32_16x16x32_bf16 v[104:107], v[180:183], v[152:155], v[104:107]
    buffer_load_dwordx4 v238, s[12:15], s27 offen offset:3072 sc1  lds
    v_mfma_f32_16x16x32_bf16 v[100:103], v[180:183], v[148:151], v[100:103]
    v_cndmask_b32 v128, v128, v130, s[48:49]
    v_mfma_f32_16x16x32_bf16 v[96:99], v[180:183], v[144:147], v[96:99]
    s_add_u32 m0, s23, 53248
    v_mfma_f32_16x16x32_bf16 v[112:115], v[184:187], v[144:147], v[112:115]
    s_add_u32 s28, s28, 1
    v_mfma_f32_16x16x32_bf16 v[116:119], v[184:187], v[148:151], v[116:119]
    buffer_load_dwordx4 v4, s[8:11], s26 offen offset:0 sc1  lds
    v_cndmask_b32 v128, v128, v131, s[50:51]
    v_mfma_f32_16x16x32_bf16 v[120:123], v[184:187], v[152:155], v[120:123]
    v_or_b32 v133, 0x80000000, v128
    v_mfma_f32_16x16x32_bf16 v[124:127], v[184:187], v[156:159], v[124:127]
    s_mov_b64 exec, s[52:53]
    global_store_dwordx2 v254, v[132:133], s[4:5] sc1
    s_mov_b64 exec, -1
    s_waitcnt lgkmcnt(0)
    v_mfma_f32_16x16x32_bf16 v[16:19], v[204:207], v[188:191], v[16:19]
    v_mfma_f32_16x16x32_bf16 v[20:23], v[204:207], v[192:195], v[20:23]
    v_mfma_f32_16x16x32_bf16 v[24:27], v[204:207], v[196:199], v[24:27]
    buffer_load_dwordx4 v5, s[8:11], s26 offen offset:1024 sc1  lds
    v_mfma_f32_16x16x32_bf16 v[28:31], v[204:207], v[200:203], v[28:31]
    s_add_u32 s27, s27, s56
    v_mfma_f32_16x16x32_bf16 v[44:47], v[208:211], v[200:203], v[44:47]
    s_add_u32 m0, s29, 61440
    v_mfma_f32_16x16x32_bf16 v[40:43], v[208:211], v[196:199], v[40:43]
    s_and_b32 s28, s28, 7
    v_mfma_f32_16x16x32_bf16 v[36:39], v[208:211], v[192:195], v[36:39]
    buffer_load_dwordx4 v4, s[12:15], s27 offen offset:0 sc1  lds
    v_mfma_f32_16x16x32_bf16 v[32:35], v[208:211], v[188:191], v[32:35]
    s_waitcnt vmcnt(12)
    s_barrier
    v_mfma_f32_16x16x32_bf16 v[48:51], v[212:215], v[188:191], v[48:51]
    ds_read_b128 v[160:163], v14 offset:0
    v_mfma_f32_16x16x32_bf16 v[52:55], v[212:215], v[192:195], v[52:55]
    ds_read_b64_tr_b16 v[144:145], v10 offset:0
    v_mfma_f32_16x16x32_bf16 v[56:59], v[212:215], v[196:199], v[56:59]
    ds_read_b64_tr_b16 v[146:147], v10 offset:4096
    buffer_load_dwordx4 v5, s[12:15], s27 offen offset:1024 sc1  lds
    v_mfma_f32_16x16x32_bf16 v[60:63], v[212:215], v[200:203], v[60:63]
    ds_read_b64_tr_b16 v[148:149], v11 offset:0
    v_mfma_f32_16x16x32_bf16 v[76:79], v[216:219], v[200:203], v[76:79]
    ds_read_b64_tr_b16 v[150:151], v11 offset:4096
    v_mfma_f32_16x16x32_bf16 v[72:75], v[216:219], v[196:199], v[72:75]
    ds_read_b64_tr_b16 v[152:153], v12 offset:0
    v_mfma_f32_16x16x32_bf16 v[68:71], v[216:219], v[192:195], v[68:71]
    ds_read_b64_tr_b16 v[154:155], v12 offset:4096
    buffer_load_dwordx4 v6, s[12:15], s27 offen offset:2048 sc1  lds
    v_mfma_f32_16x16x32_bf16 v[64:67], v[216:219], v[188:191], v[64:67]
    ds_read_b64_tr_b16 v[156:157], v13 offset:0
    s_lshl_b32 s26, s28, 15
    v_mfma_f32_16x16x32_bf16 v[80:83], v[220:223], v[188:191], v[80:83]
    ds_read_b64_tr_b16 v[158:159], v13 offset:4096
    s_add_u32 m0, s23, 90112
    v_mfma_f32_16x16x32_bf16 v[84:87], v[220:223], v[192:195], v[84:87]
    ds_read_b128 v[164:167], v14 offset:1024
    s_mul_i32 s27, s28, 57344
    v_mfma_f32_16x16x32_bf16 v[88:91], v[220:223], v[196:199], v[88:91]
    ds_read_b128 v[168:171], v14 offset:2048
    buffer_load_dwordx4 v4, s[8:11], s26 offen offset:0 sc1  lds
    v_mfma_f32_16x16x32_bf16 v[92:95], v[220:223], v[200:203], v[92:95]
    ds_read_b128 v[172:175], v14 offset:3072
    v_mfma_f32_16x16x32_bf16 v[108:111], v[224:227], v[200:203], v[108:111]
    ds_read_b128 v[176:179], v14 offset:4096
    v_mfma_f32_16x16x32_bf16 v[104:107], v[224:227], v[196:199], v[104:107]
    ds_read_b128 v[180:183], v14 offset:5120
    v_mfma_f32_16x16x32_bf16 v[100:103], v[224:227], v[192:195], v[100:103]
    ds_read_b128 v[184:187], v14 offset:6144
    buffer_load_dwordx4 v5, s[8:11], s26 offen offset:1024 sc1  lds
    v_mfma_f32_16x16x32_bf16 v[96:99], v[224:227], v[188:191], v[96:99]
    v_mfma_f32_16x16x32_bf16 v[112:115], v[228:231], v[188:191], v[112:115]
    s_add_u32 m0, s24, 106496
    v_mfma_f32_16x16x32_bf16 v[116:119], v[228:231], v[192:195], v[116:119]
    s_add_u32 s26, s26, 16384
    v_mfma_f32_16x16x32_bf16 v[120:123], v[228:231], v[196:199], v[120:123]
    buffer_load_dwordx4 v4, s[12:15], s27 offen offset:0 sc1  lds
    v_mfma_f32_16x16x32_bf16 v[124:127], v[228:231], v[200:203], v[124:127]
    s_waitcnt lgkmcnt(0)
    v_mfma_f32_16x16x32_bf16 v[16:19], v[160:163], v[144:147], v[16:19]
    ds_read_b128 v[204:207], v14 offset:14336
    v_mfma_f32_16x16x32_bf16 v[20:23], v[160:163], v[148:151], v[20:23]
    ds_read_b64_tr_b16 v[188:189], v10 offset:8192
    v_mfma_f32_16x16x32_bf16 v[24:27], v[160:163], v[152:155], v[24:27]
    ds_read_b64_tr_b16 v[190:191], v10 offset:12288
    buffer_load_dwordx4 v5, s[12:15], s27 offen offset:1024 sc1  lds
    v_mfma_f32_16x16x32_bf16 v[28:31], v[160:163], v[156:159], v[28:31]
    ds_read_b64_tr_b16 v[192:193], v11 offset:8192
    v_mfma_f32_16x16x32_bf16 v[44:47], v[164:167], v[156:159], v[44:47]
    ds_read_b64_tr_b16 v[194:195], v11 offset:12288
    v_mfma_f32_16x16x32_bf16 v[40:43], v[164:167], v[152:155], v[40:43]
    ds_read_b64_tr_b16 v[196:197], v12 offset:8192
    v_mfma_f32_16x16x32_bf16 v[36:39], v[164:167], v[148:151], v[36:39]
    ds_read_b64_tr_b16 v[198:199], v12 offset:12288
    buffer_load_dwordx4 v6, s[12:15], s27 offen offset:2048 sc1  lds
    v_mfma_f32_16x16x32_bf16 v[32:35], v[164:167], v[144:147], v[32:35]
    ds_read_b64_tr_b16 v[200:201], v13 offset:8192
    v_mfma_f32_16x16x32_bf16 v[48:51], v[168:171], v[144:147], v[48:51]
    ds_read_b64_tr_b16 v[202:203], v13 offset:12288
    v_mfma_f32_16x16x32_bf16 v[52:55], v[168:171], v[148:151], v[52:55]
    ds_read_b128 v[208:211], v14 offset:15360
    v_mfma_f32_16x16x32_bf16 v[56:59], v[168:171], v[152:155], v[56:59]
    ds_read_b128 v[212:215], v14 offset:16384
    buffer_load_dwordx4 v238, s[12:15], s27 offen offset:3072 sc1  lds
    v_mfma_f32_16x16x32_bf16 v[60:63], v[168:171], v[156:159], v[60:63]
    ds_read_b128 v[216:219], v14 offset:17408
    v_mfma_f32_16x16x32_bf16 v[76:79], v[172:175], v[156:159], v[76:79]
    ds_read_b128 v[220:223], v14 offset:18432
    s_add_u32 m0, s23, 98304
    v_mfma_f32_16x16x32_bf16 v[72:75], v[172:175], v[152:155], v[72:75]
    ds_read_b128 v[224:227], v14 offset:19456
    s_add_u32 s28, s28, 1
    v_mfma_f32_16x16x32_bf16 v[68:71], v[172:175], v[148:151], v[68:71]
    ds_read_b128 v[228:231], v14 offset:20480
    buffer_load_dwordx4 v4, s[8:11], s26 offen offset:0 sc1  lds
    v_mfma_f32_16x16x32_bf16 v[64:67], v[172:175], v[144:147], v[64:67]
    v_add_u32 v10, 45056, v10
    v_mfma_f32_16x16x32_bf16 v[80:83], v[176:179], v[144:147], v[80:83]
    v_add_u32 v11, 45056, v11
    v_mfma_f32_16x16x32_bf16 v[84:87], v[176:179], v[148:151], v[84:87]
    v_add_u32 v12, 45056, v12
    v_mfma_f32_16x16x32_bf16 v[88:91], v[176:179], v[152:155], v[88:91]
    v_add_u32 v13, 45056, v13
    buffer_load_dwordx4 v5, s[8:11], s26 offen offset:1024 sc1  lds
    v_mfma_f32_16x16x32_bf16 v[92:95], v[176:179], v[156:159], v[92:95]
    v_add_u32 v14, 45056, v14
    v_mfma_f32_16x16x32_bf16 v[108:111], v[180:183], v[156:159], v[108:111]
    v_mfma_f32_16x16x32_bf16 v[104:107], v[180:183], v[152:155], v[104:107]
    v_mfma_f32_16x16x32_bf16 v[100:103], v[180:183], v[148:151], v[100:103]
    global_load_dwordx2 v[128:129], v255, s[4:5] offset:0 sc1
    v_mfma_f32_16x16x32_bf16 v[96:99], v[180:183], v[144:147], v[96:99]
    s_add_u32 s27, s27, s56
    v_mfma_f32_16x16x32_bf16 v[112:115], v[184:187], v[144:147], v[112:115]
    s_add_u32 m0, s29, 106496
    v_mfma_f32_16x16x32_bf16 v[116:119], v[184:187], v[148:151], v[116:119]
    s_and_b32 s28, s28, 7
    v_mfma_f32_16x16x32_bf16 v[120:123], v[184:187], v[152:155], v[120:123]
    buffer_load_dwordx4 v4, s[12:15], s27 offen offset:0 sc1  lds
    v_mfma_f32_16x16x32_bf16 v[124:127], v[184:187], v[156:159], v[124:127]
    s_waitcnt lgkmcnt(0)
    v_mfma_f32_16x16x32_bf16 v[16:19], v[204:207], v[188:191], v[16:19]
    v_mfma_f32_16x16x32_bf16 v[20:23], v[204:207], v[192:195], v[20:23]
    v_mfma_f32_16x16x32_bf16 v[24:27], v[204:207], v[196:199], v[24:27]
    buffer_load_dwordx4 v5, s[12:15], s27 offen offset:1024 sc1  lds
    v_mfma_f32_16x16x32_bf16 v[28:31], v[204:207], v[200:203], v[28:31]
    v_mfma_f32_16x16x32_bf16 v[44:47], v[208:211], v[200:203], v[44:47]
    v_mfma_f32_16x16x32_bf16 v[40:43], v[208:211], v[196:199], v[40:43]
    v_mfma_f32_16x16x32_bf16 v[36:39], v[208:211], v[192:195], v[36:39]
    buffer_load_dwordx4 v6, s[12:15], s27 offen offset:2048 sc1  lds
    v_mfma_f32_16x16x32_bf16 v[32:35], v[208:211], v[188:191], v[32:35]
    s_waitcnt vmcnt(12)
    s_barrier
    v_mfma_f32_16x16x32_bf16 v[48:51], v[212:215], v[188:191], v[48:51]
    ds_read_b128 v[160:163], v14 offset:0
    v_mfma_f32_16x16x32_bf16 v[52:55], v[212:215], v[192:195], v[52:55]
    ds_read_b64_tr_b16 v[144:145], v10 offset:0
    v_mfma_f32_16x16x32_bf16 v[56:59], v[212:215], v[196:199], v[56:59]
    ds_read_b64_tr_b16 v[146:147], v10 offset:4096
    global_load_dwordx2 v[130:131], v255, s[4:5] offset:128 sc1
    v_mfma_f32_16x16x32_bf16 v[60:63], v[212:215], v[200:203], v[60:63]
    ds_read_b64_tr_b16 v[148:149], v11 offset:0
    s_lshl_b32 s26, s28, 15
    v_mfma_f32_16x16x32_bf16 v[76:79], v[216:219], v[200:203], v[76:79]
    ds_read_b64_tr_b16 v[150:151], v11 offset:4096
    s_add_u32 m0, s23, 0
    v_mfma_f32_16x16x32_bf16 v[72:75], v[216:219], v[196:199], v[72:75]
    ds_read_b64_tr_b16 v[152:153], v12 offset:0
    s_mul_i32 s27, s28, 57344
    v_mfma_f32_16x16x32_bf16 v[68:71], v[216:219], v[192:195], v[68:71]
    ds_read_b64_tr_b16 v[154:155], v12 offset:4096
    buffer_load_dwordx4 v4, s[8:11], s26 offen offset:0 sc1  lds
    v_mfma_f32_16x16x32_bf16 v[64:67], v[216:219], v[188:191], v[64:67]
    ds_read_b64_tr_b16 v[156:157], v13 offset:0
    v_mfma_f32_16x16x32_bf16 v[80:83], v[220:223], v[188:191], v[80:83]
    ds_read_b64_tr_b16 v[158:159], v13 offset:4096
    v_mfma_f32_16x16x32_bf16 v[84:87], v[220:223], v[192:195], v[84:87]
    ds_read_b128 v[164:167], v14 offset:1024
    v_mfma_f32_16x16x32_bf16 v[88:91], v[220:223], v[196:199], v[88:91]
    ds_read_b128 v[168:171], v14 offset:2048
    buffer_load_dwordx4 v5, s[8:11], s26 offen offset:1024 sc1  lds
    v_mfma_f32_16x16x32_bf16 v[92:95], v[220:223], v[200:203], v[92:95]
    ds_read_b128 v[172:175], v14 offset:3072
    v_mfma_f32_16x16x32_bf16 v[108:111], v[224:227], v[200:203], v[108:111]
    ds_read_b128 v[176:179], v14 offset:4096
    v_mfma_f32_16x16x32_bf16 v[104:107], v[224:227], v[196:199], v[104:107]
    ds_read_b128 v[180:183], v14 offset:5120
    v_mfma_f32_16x16x32_bf16 v[100:103], v[224:227], v[192:195], v[100:103]
    ds_read_b128 v[184:187], v14 offset:6144
    global_load_dwordx2 v[132:133], v255, s[4:5] offset:512 sc1
    v_mfma_f32_16x16x32_bf16 v[96:99], v[224:227], v[188:191], v[96:99]
    v_mfma_f32_16x16x32_bf16 v[112:115], v[228:231], v[188:191], v[112:115]
    s_add_u32 m0, s24, 16384
    v_mfma_f32_16x16x32_bf16 v[116:119], v[228:231], v[192:195], v[116:119]
    s_add_u32 s26, s26, 16384
    v_mfma_f32_16x16x32_bf16 v[120:123], v[228:231], v[196:199], v[120:123]
    buffer_load_dwordx4 v4, s[12:15], s27 offen offset:0 sc1  lds
    v_mfma_f32_16x16x32_bf16 v[124:127], v[228:231], v[200:203], v[124:127]
    s_waitcnt lgkmcnt(0)
    v_mfma_f32_16x16x32_bf16 v[16:19], v[160:163], v[144:147], v[16:19]
    ds_read_b128 v[204:207], v14 offset:14336
    v_mfma_f32_16x16x32_bf16 v[20:23], v[160:163], v[148:151], v[20:23]
    ds_read_b64_tr_b16 v[188:189], v10 offset:8192
    v_mfma_f32_16x16x32_bf16 v[24:27], v[160:163], v[152:155], v[24:27]
    ds_read_b64_tr_b16 v[190:191], v10 offset:12288
    buffer_load_dwordx4 v5, s[12:15], s27 offen offset:1024 sc1  lds
    v_mfma_f32_16x16x32_bf16 v[28:31], v[160:163], v[156:159], v[28:31]
    ds_read_b64_tr_b16 v[192:193], v11 offset:8192
    v_mfma_f32_16x16x32_bf16 v[44:47], v[164:167], v[156:159], v[44:47]
    ds_read_b64_tr_b16 v[194:195], v11 offset:12288
    v_mfma_f32_16x16x32_bf16 v[40:43], v[164:167], v[152:155], v[40:43]
    ds_read_b64_tr_b16 v[196:197], v12 offset:8192
    v_mfma_f32_16x16x32_bf16 v[36:39], v[164:167], v[148:151], v[36:39]
    ds_read_b64_tr_b16 v[198:199], v12 offset:12288
    buffer_load_dwordx4 v6, s[12:15], s27 offen offset:2048 sc1  lds
    v_mfma_f32_16x16x32_bf16 v[32:35], v[164:167], v[144:147], v[32:35]
    ds_read_b64_tr_b16 v[200:201], v13 offset:8192
    v_mfma_f32_16x16x32_bf16 v[48:51], v[168:171], v[144:147], v[48:51]
    ds_read_b64_tr_b16 v[202:203], v13 offset:12288
    v_mfma_f32_16x16x32_bf16 v[52:55], v[168:171], v[148:151], v[52:55]
    ds_read_b128 v[208:211], v14 offset:15360
    v_mfma_f32_16x16x32_bf16 v[56:59], v[168:171], v[152:155], v[56:59]
    ds_read_b128 v[212:215], v14 offset:16384
    global_load_dwordx2 v[134:135], v255, s[4:5] offset:640 sc1
    v_mfma_f32_16x16x32_bf16 v[60:63], v[168:171], v[156:159], v[60:63]
    ds_read_b128 v[216:219], v14 offset:17408
    v_mfma_f32_16x16x32_bf16 v[76:79], v[172:175], v[156:159], v[76:79]
    ds_read_b128 v[220:223], v14 offset:18432
    v_mfma_f32_16x16x32_bf16 v[72:75], v[172:175], v[152:155], v[72:75]
    ds_read_b128 v[224:227], v14 offset:19456
    v_mfma_f32_16x16x32_bf16 v[68:71], v[172:175], v[148:151], v[68:71]
    ds_read_b128 v[228:231], v14 offset:20480
    buffer_load_dwordx4 v238, s[12:15], s27 offen offset:3072 sc1  lds
    v_mfma_f32_16x16x32_bf16 v[64:67], v[172:175], v[144:147], v[64:67]
    v_add_u32 v10, 45056, v10
    v_mfma_f32_16x16x32_bf16 v[80:83], v[176:179], v[144:147], v[80:83]
    v_add_u32 v11, 45056, v11
    s_add_u32 m0, s23, 8192
    v_mfma_f32_16x16x32_bf16 v[84:87], v[176:179], v[148:151], v[84:87]
    v_add_u32 v12, 45056, v12
    s_add_u32 s28, s28, 1
    v_mfma_f32_16x16x32_bf16 v[88:91], v[176:179], v[152:155], v[88:91]
    v_add_u32 v13, 45056, v13
    buffer_load_dwordx4 v4, s[8:11], s26 offen offset:0 sc1  lds
    v_mfma_f32_16x16x32_bf16 v[92:95], v[176:179], v[156:159], v[92:95]
    v_add_u32 v14, 45056, v14
    v_mfma_f32_16x16x32_bf16 v[108:111], v[180:183], v[156:159], v[108:111]
    v_mfma_f32_16x16x32_bf16 v[104:107], v[180:183], v[152:155], v[104:107]
    v_mfma_f32_16x16x32_bf16 v[100:103], v[180:183], v[148:151], v[100:103]
    buffer_load_dwordx4 v5, s[8:11], s26 offen offset:1024 sc1  lds
    v_mfma_f32_16x16x32_bf16 v[96:99], v[180:183], v[144:147], v[96:99]
    s_add_u32 s27, s27, s56
    v_mfma_f32_16x16x32_bf16 v[112:115], v[184:187], v[144:147], v[112:115]
    s_add_u32 m0, s29, 16384
    v_mfma_f32_16x16x32_bf16 v[116:119], v[184:187], v[148:151], v[116:119]
    s_and_b32 s28, s28, 7
    v_mfma_f32_16x16x32_bf16 v[120:123], v[184:187], v[152:155], v[120:123]
    buffer_load_dwordx4 v4, s[12:15], s27 offen offset:0 sc1  lds
    v_mfma_f32_16x16x32_bf16 v[124:127], v[184:187], v[156:159], v[124:127]
    s_waitcnt lgkmcnt(0)
    v_mfma_f32_16x16x32_bf16 v[16:19], v[204:207], v[188:191], v[16:19]
    v_mfma_f32_16x16x32_bf16 v[20:23], v[204:207], v[192:195], v[20:23]
    v_mfma_f32_16x16x32_bf16 v[24:27], v[204:207], v[196:199], v[24:27]
    buffer_load_dwordx4 v5, s[12:15], s27 offen offset:1024 sc1  lds
    v_mfma_f32_16x16x32_bf16 v[28:31], v[204:207], v[200:203], v[28:31]
    v_mfma_f32_16x16x32_bf16 v[44:47], v[208:211], v[200:203], v[44:47]
    v_mfma_f32_16x16x32_bf16 v[40:43], v[208:211], v[196:199], v[40:43]
    v_mfma_f32_16x16x32_bf16 v[36:39], v[208:211], v[192:195], v[36:39]
    buffer_load_dwordx4 v6, s[12:15], s27 offen offset:2048 sc1  lds
    v_mfma_f32_16x16x32_bf16 v[32:35], v[208:211], v[188:191], v[32:35]
    s_waitcnt vmcnt(14)
    s_barrier
    v_mfma_f32_16x16x32_bf16 v[48:51], v[212:215], v[188:191], v[48:51]
    ds_read_b128 v[160:163], v14 offset:0
    s_lshl_b32 s26, s28, 15
    s_add_u32 m0, s23, 45056
    v_mfma_f32_16x16x32_bf16 v[52:55], v[212:215], v[192:195], v[52:55]
    ds_read_b64_tr_b16 v[144:145], v10 offset:0
    s_mul_i32 s27, s28, 57344
    v_mfma_f32_16x16x32_bf16 v[56:59], v[212:215], v[196:199], v[56:59]
    ds_read_b64_tr_b16 v[146:147], v10 offset:4096
    buffer_load_dwordx4 v4, s[8:11], s26 offen offset:0 sc1  lds
    v_mfma_f32_16x16x32_bf16 v[60:63], v[212:215], v[200:203], v[60:63]
    ds_read_b64_tr_b16 v[148:149], v11 offset:0
    v_mfma_f32_16x16x32_bf16 v[76:79], v[216:219], v[200:203], v[76:79]
    ds_read_b64_tr_b16 v[150:151], v11 offset:4096
    v_mfma_f32_16x16x32_bf16 v[72:75], v[216:219], v[196:199], v[72:75]
    ds_read_b64_tr_b16 v[152:153], v12 offset:0
    v_mfma_f32_16x16x32_bf16 v[68:71], v[216:219], v[192:195], v[68:71]
    ds_read_b64_tr_b16 v[154:155], v12 offset:4096
    buffer_load_dwordx4 v5, s[8:11], s26 offen offset:1024 sc1  lds
    v_mfma_f32_16x16x32_bf16 v[64:67], v[216:219], v[188:191], v[64:67]
    ds_read_b64_tr_b16 v[156:157], v13 offset:0
    v_mfma_f32_16x16x32_bf16 v[80:83], v[220:223], v[188:191], v[80:83]
    ds_read_b64_tr_b16 v[158:159], v13 offset:4096
    s_add_u32 m0, s24, 61440
    v_mfma_f32_16x16x32_bf16 v[84:87], v[220:223], v[192:195], v[84:87]
    ds_read_b128 v[164:167], v14 offset:1024
    s_add_u32 s26, s26, 16384
    v_mfma_f32_16x16x32_bf16 v[88:91], v[220:223], v[196:199], v[88:91]
    ds_read_b128 v[168:171], v14 offset:2048
    buffer_load_dwordx4 v4, s[12:15], s27 offen offset:0 sc1  lds
    v_mfma_f32_16x16x32_bf16 v[92:95], v[220:223], v[200:203], v[92:95]
    ds_read_b128 v[172:175], v14 offset:3072
    v_mfma_f32_16x16x32_bf16 v[108:111], v[224:227], v[200:203], v[108:111]
    ds_read_b128 v[176:179], v14 offset:4096
    v_mfma_f32_16x16x32_bf16 v[104:107], v[224:227], v[196:199], v[104:107]
    ds_read_b128 v[180:183], v14 offset:5120
    v_mfma_f32_16x16x32_bf16 v[100:103], v[224:227], v[192:195], v[100:103]
    ds_read_b128 v[184:187], v14 offset:6144
    buffer_load_dwordx4 v5, s[12:15], s27 offen offset:1024 sc1  lds
    v_mfma_f32_16x16x32_bf16 v[96:99], v[224:227], v[188:191], v[96:99]
    v_mfma_f32_16x16x32_bf16 v[112:115], v[228:231], v[188:191], v[112:115]
    v_mfma_f32_16x16x32_bf16 v[116:119], v[228:231], v[192:195], v[116:119]
    v_mfma_f32_16x16x32_bf16 v[120:123], v[228:231], v[196:199], v[120:123]
    buffer_load_dwordx4 v6, s[12:15], s27 offen offset:2048 sc1  lds
    v_mfma_f32_16x16x32_bf16 v[124:127], v[228:231], v[200:203], v[124:127]
    s_waitcnt lgkmcnt(0)
    v_mfma_f32_16x16x32_bf16 v[16:19], v[160:163], v[144:147], v[16:19]
    ds_read_b128 v[204:207], v14 offset:14336
    v_mfma_f32_16x16x32_bf16 v[20:23], v[160:163], v[148:151], v[20:23]
    ds_read_b64_tr_b16 v[188:189], v10 offset:8192
    v_mfma_f32_16x16x32_bf16 v[24:27], v[160:163], v[152:155], v[24:27]
    ds_read_b64_tr_b16 v[190:191], v10 offset:12288
    buffer_load_dwordx4 v238, s[12:15], s27 offen offset:3072 sc1  lds
    v_mfma_f32_16x16x32_bf16 v[28:31], v[160:163], v[156:159], v[28:31]
    ds_read_b64_tr_b16 v[192:193], v11 offset:8192
    v_mfma_f32_16x16x32_bf16 v[44:47], v[164:167], v[156:159], v[44:47]
    ds_read_b64_tr_b16 v[194:195], v11 offset:12288
    s_add_u32 m0, s23, 53248
    v_mfma_f32_16x16x32_bf16 v[40:43], v[164:167], v[152:155], v[40:43]
    ds_read_b64_tr_b16 v[196:197], v12 offset:8192
    s_add_u32 s28, s28, 1
    v_mfma_f32_16x16x32_bf16 v[36:39], v[164:167], v[148:151], v[36:39]
    ds_read_b64_tr_b16 v[198:199], v12 offset:12288
    buffer_load_dwordx4 v4, s[8:11], s26 offen offset:0 sc1  lds
    v_mfma_f32_16x16x32_bf16 v[32:35], v[164:167], v[144:147], v[32:35]
    ds_read_b64_tr_b16 v[200:201], v13 offset:8192
    v_mfma_f32_16x16x32_bf16 v[48:51], v[168:171], v[144:147], v[48:51]
    ds_read_b64_tr_b16 v[202:203], v13 offset:12288
    v_mfma_f32_16x16x32_bf16 v[52:55], v[168:171], v[148:151], v[52:55]
    ds_read_b128 v[208:211], v14 offset:15360
    v_mfma_f32_16x16x32_bf16 v[56:59], v[168:171], v[152:155], v[56:59]
    ds_read_b128 v[212:215], v14 offset:16384
    buffer_load_dwordx4 v5, s[8:11], s26 offen offset:1024 sc1  lds
    v_mfma_f32_16x16x32_bf16 v[60:63], v[168:171], v[156:159], v[60:63]
    ds_read_b128 v[216:219], v14 offset:17408
    s_add_u32 s27, s27, s56
    v_mfma_f32_16x16x32_bf16 v[76:79], v[172:175], v[156:159], v[76:79]
    ds_read_b128 v[220:223], v14 offset:18432
    s_add_u32 m0, s29, 61440
    v_mfma_f32_16x16x32_bf16 v[72:75], v[172:175], v[152:155], v[72:75]
    ds_read_b128 v[224:227], v14 offset:19456
    s_and_b32 s28, s28, 7
    v_mfma_f32_16x16x32_bf16 v[68:71], v[172:175], v[148:151], v[68:71]
    ds_read_b128 v[228:231], v14 offset:20480
    buffer_load_dwordx4 v4, s[12:15], s27 offen offset:0 sc1  lds
    v_mfma_f32_16x16x32_bf16 v[64:67], v[172:175], v[144:147], v[64:67]
    v_add_u32 v10, 4294877184, v10
    v_mfma_f32_16x16x32_bf16 v[80:83], v[176:179], v[144:147], v[80:83]
    v_add_u32 v11, 4294877184, v11
    s_waitcnt vmcnt(15)
    v_mfma_f32_16x16x32_bf16 v[84:87], v[176:179], v[148:151], v[84:87]
    v_add_u32 v12, 4294877184, v12
    v_mfma_f32_16x16x32_bf16 v[88:91], v[176:179], v[152:155], v[88:91]
    v_add_u32 v13, 4294877184, v13
    buffer_load_dwordx4 v5, s[12:15], s27 offen offset:1024 sc1  lds
    v_mfma_f32_16x16x32_bf16 v[92:95], v[176:179], v[156:159], v[92:95]
    v_add_u32 v14, 4294877184, v14
    v_mfma_f32_16x16x32_bf16 v[108:111], v[180:183], v[156:159], v[108:111]
    v_and_b32 v232, v129, v131
    v_and_b32 v233, v133, v135
    v_mfma_f32_16x16x32_bf16 v[104:107], v[180:183], v[152:155], v[104:107]
    v_and_b32 v232, v232, v233
    v_cmp_le_i32 vcc, 0, v232
    v_mfma_f32_16x16x32_bf16 v[100:103], v[180:183], v[148:151], v[100:103]
    buffer_load_dwordx4 v6, s[12:15], s27 offen offset:2048 sc1  lds
    v_mfma_f32_16x16x32_bf16 v[96:99], v[180:183], v[144:147], v[96:99]
    s_cbranch_vccnz L_retry
L_ok:
    v_add_f32 v128, v128, v132
    v_mfma_f32_16x16x32_bf16 v[112:115], v[184:187], v[144:147], v[112:115]
    v_add_f32 v129, v129, v133
    v_mfma_f32_16x16x32_bf16 v[116:119], v[184:187], v[148:151], v[116:119]
    v_add_f32 v130, v130, v134
    v_add_f32 v131, v131, v135
    v_mfma_f32_16x16x32_bf16 v[120:123], v[184:187], v[152:155], v[120:123]
    global_load_dwordx4 a[224:227], v15, s[4:5] offset:-4096 sc1
    v_mfma_f32_16x16x32_bf16 v[124:127], v[184:187], v[156:159], v[124:127]
    v_add_f32 v128, v128, v130
    v_add_f32 v129, v129, v131
    s_waitcnt lgkmcnt(0)
    v_mfma_f32_16x16x32_bf16 v[16:19], v[204:207], v[188:191], v[16:19]
    v_mfma_f32_16x16x32_bf16 v[20:23], v[204:207], v[192:195], v[20:23]
    v_mfma_f32_16x16x32_bf16 v[24:27], v[204:207], v[196:199], v[24:27]
    global_load_dwordx4 a[228:231], v15, s[4:5] offset:-2048 sc1
T_f2_3_0:
    s_cbranch_execz T_f2_3_1
    v_mfma_f32_16x16x32_bf16 v[28:31], v[204:207], v[200:203], v[28:31]
    s_waitcnt vmcnt(13)
    s_barrier
    v_mfma_f32_16x16x32_bf16 v[44:47], v[208:211], v[200:203], v[44:47]
    ds_read_b128 v[176:179], v14 offset:0
    v_mul_f32 v128, 0xbb000000, v128
    v_mfma_f32_16x16x32_bf16 v[40:43], v[208:211], v[196:199], v[40:43]
    ds_read_b64_tr_b16 v[144:145], v10 offset:0
    v_mfma_f32_16x16x32_bf16 v[36:39], v[208:211], v[192:195], v[36:39]
    ds_read_b64_tr_b16 v[146:147], v10 offset:4096
    global_load_dwordx4 a[232:235], v15, s[4:5] offset:0 sc1
    v_mfma_f32_16x16x32_bf16 v[32:35], v[208:211], v[188:191], v[32:35]
    ds_read_b64_tr_b16 v[148:149], v11 offset:0
    v_mul_f32 v129, 0xbb000000, v129
    v_mfma_f32_16x16x32_bf16 v[48:51], v[212:215], v[188:191], v[48:51]
    ds_read_b64_tr_b16 v[150:151], v11 offset:4096
    v_mfma_f32_16x16x32_bf16 v[52:55], v[212:215], v[192:195], v[52:55]
    ds_read_b64_tr_b16 v[152:153], v12 offset:0
    v_fma_f32 v129, -v128, v128, v129
    v_mfma_f32_16x16x32_bf16 v[56:59], v[212:215], v[196:199], v[56:59]
    ds_read_b64_tr_b16 v[154:155], v12 offset:4096
    global_load_dwordx4 a[236:239], v15, s[4:5] offset:2048 sc1
    v_mfma_f32_16x16x32_bf16 v[60:63], v[212:215], v[200:203], v[60:63]
    ds_read_b64_tr_b16 v[156:157], v13 offset:0
T_f2_3_1:
    s_cbranch_execz T_f2_back
    v_mfma_f32_16x16x32_bf16 v[76:79], v[216:219], v[200:203], v[76:79]
    ds_read_b64_tr_b16 v[158:159], v13 offset:4096
    v_max_f32 v129, 0, v129
    v_mfma_f32_16x16x32_bf16 v[72:75], v[216:219], v[196:199], v[72:75]
    ds_read_b128 v[180:183], v14 offset:14336
    v_mfma_f32_16x16x32_bf16 v[68:71], v[216:219], v[192:195], v[68:71]
    ds_read_b64_tr_b16 v[160:161], v10 offset:8192
    global_load_dwordx4 a[240:243], v239, s[4:5] offset:-4096 sc1
    v_mfma_f32_16x16x32_bf16 v[64:67], v[216:219], v[188:191], v[64:67]
    ds_read_b64_tr_b16 v[162:163], v10 offset:12288
    v_add_f32 v129, 0x3727c5ac, v129
    v_mfma_f32_16x16x32_bf16 v[80:83], v[220:223], v[188:191], v[80:83]
    ds_read_b64_tr_b16 v[164:165], v11 offset:8192
    v_mfma_f32_16x16x32_bf16 v[84:87], v[220:223], v[192:195], v[84:87]
    ds_read_b64_tr_b16 v[166:167], v11 offset:12288
    v_sqrt_f32 v129, v129
    v_mfma_f32_16x16x32_bf16 v[88:91], v[220:223], v[196:199], v[88:91]
    ds_read_b64_tr_b16 v[168:169], v12 offset:8192
    global_load_dwordx4 a[244:247], v239, s[4:5] offset:-2048 sc1
    v_mfma_f32_16x16x32_bf16 v[92:95], v[220:223], v[200:203], v[92:95]
    ds_read_b64_tr_b16 v[170:171], v12 offset:12288
    v_mfma_f32_16x16x32_bf16 v[108:111], v[224:227], v[200:203], v[108:111]
    ds_read_b64_tr_b16 v[172:173], v13 offset:8192
    v_cvt_pk_bf16_f32 v132, v128, v129
    v_mfma_f32_16x16x32_bf16 v[104:107], v[224:227], v[196:199], v[104:107]
    ds_read_b64_tr_b16 v[174:175], v13 offset:12288
    v_mfma_f32_16x16x32_bf16 v[100:103], v[224:227], v[192:195], v[100:103]
    ds_read_b128 v[184:187], v14 offset:1024
    global_load_dwordx4 a[248:251], v239, s[4:5] offset:0 sc1
    v_mfma_f32_16x16x32_bf16 v[96:99], v[224:227], v[188:191], v[96:99]
    v_cvt_pk_bf16_f32 v140, v128, v129
    v_cvt_pk_bf16_f32 v136, v128, v129
    v_mfma_f32_16x16x32_bf16 v[112:115], v[228:231], v[188:191], v[112:115]
    s_add_u32 m0, s24, 147456
    v_mfma_f32_16x16x32_bf16 v[116:119], v[228:231], v[192:195], v[116:119]
    s_mul_i32 s44, s61, 38
    v_cvt_pk_bf16_f32 v128, v128, v129
    v_mfma_f32_16x16x32_bf16 v[120:123], v[228:231], v[196:199], v[120:123]
    buffer_load_dwordx4 v240, s[40:43], s44 offen offset:0 sc1 lds
    v_mfma_f32_16x16x32_bf16 v[124:127], v[228:231], v[200:203], v[124:127]
    v_permlane32_swap_b32 v132, v140
    v_permlane32_swap_b32 v128, v136
    s_waitcnt lgkmcnt(0)
    v_mfma_f32_16x16x32_bf16 v[16:19], v[176:179], v[144:147], v[16:19]
    v_add_u32 v238, 45056, v14
    ds_read_b128 v[220:223], v14 offset:15360
    v_mfma_f32_16x16x32_bf16 v[20:23], v[176:179], v[148:151], v[20:23]
    buffer_load_dwordx4 v241, s[40:43], s44 offen offset:1024 sc1 lds
    ds_read_b128 v[224:227], v14 offset:2048
    v_mfma_f32_16x16x32_bf16 v[24:27], v[176:179], v[152:155], v[24:27]
    ds_read_b128 v[228:231], v14 offset:16384
    v_permlane16_swap_b32 v128, v132
    v_mfma_f32_16x16x32_bf16 v[28:31], v[176:179], v[156:159], v[28:31]
    v_permlane16_swap_b32 v136, v140
    v_mov_b32 v129, v128
    v_mfma_f32_16x16x32_bf16 v[28:31], v[180:183], v[172:175], v[28:31]
    buffer_load_dwordx4 v242, s[40:43], s44 offen offset:2048 sc1 lds
    v_mov_b32 v130, v128
    v_mfma_f32_16x16x32_bf16 v[24:27], v[180:183], v[168:171], v[24:27]
    v_mov_b32 v131, v128
    v_mov_b32 v133, v132
    v_mfma_f32_16x16x32_bf16 v[20:23], v[180:183], v[164:167], v[20:23]
    v_mov_b32 v134, v132
    v_mov_b32 v135, v132
    v_mfma_f32_16x16x32_bf16 v[16:19], v[180:183], v[160:163], v[16:19]
    buffer_load_dwordx4 v243, s[40:43], s44 offen offset:3072 sc1 lds
    v_mov_b32 v137, v136
    v_mfma_f32_16x16x32_bf16 v[32:35], v[184:187], v[144:147], v[32:35]
    v_mov_b32 v138, v136
    v_mov_b32 v139, v136
    v_mfma_f32_16x16x32_bf16 v[36:39], v[184:187], v[148:151], v[36:39]
    v_mov_b32 v141, v140
    v_mov_b32 v142, v140
    v_mfma_f32_16x16x32_bf16 v[40:43], v[184:187], v[152:155], v[40:43]
    s_add_u32 m0, s24, 90112
    s_mul_i32 s44, s61, 45
    buffer_load_dwordx4 v240, s[40:43], s44 offen offset:0 sc1 lds
    v_mov_b32 v143, v140
    v_mfma_f32_16x16x32_bf16 v[44:47], v[184:187], v[156:159], v[44:47]
    v_xor_b32 v5, s59, v4
    v_add_u32 v5, s58, v5
    s_waitcnt vmcnt(12)
    s_barrier
    s_waitcnt lgkmcnt(2)
    v_mfma_f32_16x16x32_bf16 v[44:47], v[220:223], v[172:175], v[44:47]
    ds_read_b128 v[176:179], v238 offset:0
    ds_read_b64_tr_b16 v[188:189], v10 offset:45056
    v_mfma_f32_16x16x32_bf16 v[40:43], v[220:223], v[168:171], v[40:43]
    ds_read_b128 v[180:183], v238 offset:14336
    ds_read_b64_tr_b16 v[190:191], v10 offset:49152
    v_mfma_f32_16x16x32_bf16 v[36:39], v[220:223], v[164:167], v[36:39]
    ds_read_b128 v[184:187], v238 offset:1024
    ds_read_b64_tr_b16 v[192:193], v11 offset:45056
    v_mfma_f32_16x16x32_bf16 v[32:35], v[220:223], v[160:163], v[32:35]
    buffer_load_dwordx4 v241, s[40:43], s44 offen offset:1024 sc1 lds
    ds_read_b64_tr_b16 v[194:195], v11 offset:49152
    s_waitcnt lgkmcnt(8)
    v_mfma_f32_16x16x32_bf16 v[48:51], v[224:227], v[144:147], v[48:51]
    ds_read_b128 v[220:223], v238 offset:15360
    ds_read_b64_tr_b16 v[196:197], v12 offset:45056
    v_mfma_f32_16x16x32_bf16 v[52:55], v[224:227], v[148:151], v[52:55]
    ds_read_b64_tr_b16 v[198:199], v12 offset:49152
    ds_read_b64_tr_b16 v[200:201], v13 offset:45056
    v_mfma_f32_16x16x32_bf16 v[56:59], v[224:227], v[152:155], v[56:59]
    buffer_load_dwordx4 v242, s[40:43], s44 offen offset:2048 sc1 lds
    ds_read_b64_tr_b16 v[202:203], v13 offset:49152
    v_mfma_f32_16x16x32_bf16 v[60:63], v[224:227], v[156:159], v[60:63]
    ds_read_b64_tr_b16 v[204:205], v10 offset:53248
    ds_read_b64_tr_b16 v[206:207], v10 offset:57344
    s_waitcnt lgkmcnt(14)
    v_mfma_f32_16x16x32_bf16 v[60:63], v[228:231], v[172:175], v[60:63]
    ds_read_b128 v[224:227], v238 offset:2048
    ds_read_b64_tr_b16 v[208:209], v11 offset:53248
    v_mfma_f32_16x16x32_bf16 v[56:59], v[228:231], v[168:171], v[56:59]
    buffer_load_dwordx4 v243, s[40:43], s44 offen offset:3072 sc1 lds
    ds_read_b64_tr_b16 v[210:211], v11 offset:57344
    v_mfma_f32_16x16x32_bf16 v[52:55], v[228:231], v[164:167], v[52:55]
    ds_read_b64_tr_b16 v[212:213], v12 offset:53248
    ds_read_b64_tr_b16 v[214:215], v12 offset:57344
    v_mfma_f32_16x16x32_bf16 v[48:51], v[228:231], v[160:163], v[48:51]
    ds_read_b64_tr_b16 v[216:217], v13 offset:53248
    ds_read_b64_tr_b16 v[218:219], v13 offset:57344
    s_waitcnt lgkmcnt(9)
    v_mfma_f32_16x16x32_bf16 v[16:19], v[176:179], v[188:191], v[16:19]
    ds_read_b128 v[228:231], v238 offset:16384
    v_add_u32 v6, s63, v5
    v_mfma_f32_16x16x32_bf16 v[20:23], v[176:179], v[192:195], v[20:23]
    s_add_u32 m0, s24, 106496
    s_mul_i32 s44, s61, 52
    buffer_load_dwordx4 v240, s[40:43], s44 offen offset:0 sc1 lds
    v_mfma_f32_16x16x32_bf16 v[24:27], v[176:179], v[196:199], v[24:27]
    v_mfma_f32_16x16x32_bf16 v[28:31], v[176:179], v[200:203], v[28:31]
    s_waitcnt lgkmcnt(1)
    v_mfma_f32_16x16x32_bf16 v[28:31], v[180:183], v[216:219], v[28:31]
    ds_read_b128 v[176:179], v14 offset:3072
    v_mfma_f32_16x16x32_bf16 v[24:27], v[180:183], v[212:215], v[24:27]
    buffer_load_dwordx4 v241, s[40:43], s44 offen offset:1024 sc1 lds
    v_mfma_f32_16x16x32_bf16 v[20:23], v[180:183], v[208:211], v[20:23]
    v_mfma_f32_16x16x32_bf16 v[16:19], v[180:183], v[204:207], v[16:19]
    s_waitcnt vmcnt(16)
    v_mfma_f32_16x16x32_bf16 v[16:19], a[224:227], v[128:131], v[16:19]
    buffer_load_dwordx4 v242, s[40:43], s44 offen offset:2048 sc1 lds
    v_mov_b32 v232, s54
    v_mfma_f32_16x16x32_bf16 v[20:23], a[224:227], v[132:135], v[20:23]
    v_mov_b32 v233, 1
    s_lshl2_add_u32 s55, s34, s22
    v_mfma_f32_16x16x32_bf16 v[24:27], a[224:227], v[136:139], v[24:27]
    s_lshl_b32 s25, s55, 10
    s_add_u32 s25, s25, 4325376
    v_mfma_f32_16x16x32_bf16 v[28:31], a[224:227], v[140:143], v[28:31]
    buffer_load_dwordx4 v243, s[40:43], s44 offen offset:3072 sc1 lds
    v_and_b32 v234, 2, v253
    v_mfma_f32_16x16x32_bf16 v[32:35], v[184:187], v[188:191], v[32:35]
    ds_read_b128 v[180:183], v14 offset:17408
    v_add_lshl_u32 v234, v234, v253, 7
    v_mfma_f32_16x16x32_bf16 v[36:39], v[184:187], v[192:195], v[36:39]
    v_lshl_add_u32 v234, v252, 3, v234
    v_add_u32 v234, s25, v234
    v_mfma_f32_16x16x32_bf16 v[40:43], v[184:187], v[196:199], v[40:43]
    v_mul_f32 v16, v16, v18
    v_mul_f32 v17, v17, v19
    v_mfma_f32_16x16x32_bf16 v[44:47], v[184:187], v[200:203], v[44:47]
    v_mul_f32 v24, v24, v26
    v_mul_f32 v25, v25, v27
    v_mfma_f32_16x16x32_bf16 v[44:47], v[220:223], v[216:219], v[44:47]
    ds_read_b128 v[184:187], v238 offset:3072
    v_mul_f32 v20, v20, v22
    v_mfma_f32_16x16x32_bf16 v[40:43], v[220:223], v[212:215], v[40:43]
    v_mul_f32 v21, v21, v23
    v_mul_f32 v28, v28, v30
    v_mfma_f32_16x16x32_bf16 v[36:39], v[220:223], v[208:211], v[36:39]
    v_mul_f32 v29, v29, v31
    v_cvt_pk_bf16_f32 v244, v16, v17
    v_mfma_f32_16x16x32_bf16 v[32:35], v[220:223], v[204:207], v[32:35]
    v_cvt_pk_bf16_f32 v246, v24, v25
    v_cvt_pk_bf16_f32 v245, v20, v21
    s_waitcnt vmcnt(17)
    v_mfma_f32_16x16x32_bf16 v[32:35], a[228:231], v[128:131], v[32:35]
    v_cvt_pk_bf16_f32 v247, v28, v29
    v_permlane32_swap_b32 v244, v246
    v_mfma_f32_16x16x32_bf16 v[36:39], a[228:231], v[132:135], v[36:39]
    v_permlane32_swap_b32 v245, v247
    s_nop 1
    v_permlane16_swap_b32 v244, v245
    v_mfma_f32_16x16x32_bf16 v[40:43], a[228:231], v[136:139], v[40:43]
    v_permlane16_swap_b32 v246, v247
    global_store_dwordx4 v5, v[244:247], s[4:5] offset:-4096 sc1
    v_mfma_f32_16x16x32_bf16 v[44:47], a[228:231], v[140:143], v[44:47]
    s_lshl_b32 s55, s55, 8
    s_add_u32 s55, s55, 4456448
    v_mfma_f32_16x16x32_bf16 v[48:51], v[224:227], v[188:191], v[48:51]
    ds_read_b128 v[220:223], v238 offset:17408
    s_lshl_b32 s25, s35, 8
    v_mfma_f32_16x16x32_bf16 v[52:55], v[224:227], v[192:195], v[52:55]
    s_add_u32 s25, s25, 4243456
    v_lshl_add_u32 v235, v253, 5, s25
    v_mfma_f32_16x16x32_bf16 v[56:59], v[224:227], v[196:199], v[56:59]
    v_mul_f32 v32, v32, v34
    v_mul_f32 v33, v33, v35
    v_mfma_f32_16x16x32_bf16 v[60:63], v[224:227], v[200:203], v[60:63]
    v_mul_f32 v40, v40, v42
    v_mul_f32 v41, v41, v43
    s_waitcnt lgkmcnt(4)
    v_mfma_f32_16x16x32_bf16 v[60:63], v[228:231], v[216:219], v[60:63]
    ds_read_b128 v[224:227], v14 offset:4096
    v_mul_f32 v36, v36, v38
    v_mfma_f32_16x16x32_bf16 v[56:59], v[228:231], v[212:215], v[56:59]
    v_mul_f32 v37, v37, v39
    v_mul_f32 v44, v44, v46
    v_mfma_f32_16x16x32_bf16 v[52:55], v[228:231], v[208:211], v[52:55]
    v_mul_f32 v45, v45, v47
    v_cvt_pk_bf16_f32 v248, v32, v33
    v_mfma_f32_16x16x32_bf16 v[48:51], v[228:231], v[204:207], v[48:51]
    v_cvt_pk_bf16_f32 v250, v40, v41
    v_cvt_pk_bf16_f32 v249, v36, v37
    s_waitcnt vmcnt(17)
    v_mfma_f32_16x16x32_bf16 v[48:51], a[232:235], v[128:131], v[48:51]
    v_cvt_pk_bf16_f32 v251, v44, v45
    v_permlane32_swap_b32 v248, v250
    v_mfma_f32_16x16x32_bf16 v[52:55], a[232:235], v[132:135], v[52:55]
    v_permlane32_swap_b32 v249, v251
    s_nop 1
    v_permlane16_swap_b32 v248, v249
    v_mfma_f32_16x16x32_bf16 v[56:59], a[232:235], v[136:139], v[56:59]
    v_permlane16_swap_b32 v250, v251
    global_store_dwordx4 v5, v[248:251], s[4:5] offset:-2048 sc1
    v_mfma_f32_16x16x32_bf16 v[60:63], a[232:235], v[140:143], v[60:63]
    v_mov_b32 v3, v252
    v_mov_b32 v4, v253
    s_waitcnt lgkmcnt(4)
    v_mfma_f32_16x16x32_bf16 v[64:67], v[176:179], v[144:147], v[64:67]
    ds_read_b128 v[228:231], v14 offset:18432
    v_xor_b32 v10, 0, v2
    v_mfma_f32_16x16x32_bf16 v[68:71], v[176:179], v[148:151], v[68:71]
    v_lshl_add_u32 v10, v10, 9, v8
    v_xor_b32 v11, 1, v2
    v_mfma_f32_16x16x32_bf16 v[72:75], v[176:179], v[152:155], v[72:75]
    v_mul_f32 v48, v48, v50
    v_mul_f32 v49, v49, v51
    v_mfma_f32_16x16x32_bf16 v[76:79], v[176:179], v[156:159], v[76:79]
    v_mul_f32 v56, v56, v58
    v_mul_f32 v57, v57, v59
    s_waitcnt lgkmcnt(4)
    v_mfma_f32_16x16x32_bf16 v[76:79], v[180:183], v[172:175], v[76:79]
    ds_read_b128 v[176:179], v238 offset:4096
    v_mul_f32 v52, v52, v54
    v_mfma_f32_16x16x32_bf16 v[72:75], v[180:183], v[168:171], v[72:75]
    v_mul_f32 v53, v53, v55
    v_mul_f32 v60, v60, v62
    v_mfma_f32_16x16x32_bf16 v[68:71], v[180:183], v[164:167], v[68:71]
    v_mul_f32 v61, v61, v63
    v_cvt_pk_bf16_f32 v244, v48, v49
    v_mfma_f32_16x16x32_bf16 v[64:67], v[180:183], v[160:163], v[64:67]
    v_cvt_pk_bf16_f32 v246, v56, v57
    v_cvt_pk_bf16_f32 v245, v52, v53
    s_waitcnt lgkmcnt(4)
    v_mfma_f32_16x16x32_bf16 v[64:67], v[184:187], v[188:191], v[64:67]
    ds_read_b128 v[180:183], v238 offset:18432
    v_cvt_pk_bf16_f32 v247, v60, v61
    v_mfma_f32_16x16x32_bf16 v[68:71], v[184:187], v[192:195], v[68:71]
    v_permlane32_swap_b32 v244, v246
    v_permlane32_swap_b32 v245, v247
    v_mfma_f32_16x16x32_bf16 v[72:75], v[184:187], v[196:199], v[72:75]
    s_nop 0
    v_permlane16_swap_b32 v244, v245
    v_permlane16_swap_b32 v246, v247
    v_mfma_f32_16x16x32_bf16 v[76:79], v[184:187], v[200:203], v[76:79]
    global_store_dwordx4 v5, v[244:247], s[4:5] offset:0 sc1
    v_lshl_add_u32 v11, v11, 9, v8
    s_waitcnt lgkmcnt(4)
    v_mfma_f32_16x16x32_bf16 v[76:79], v[220:223], v[216:219], v[76:79]
    ds_read_b128 v[184:187], v14 offset:5120
    v_xor_b32 v12, 2, v2
    v_mfma_f32_16x16x32_bf16 v[72:75], v[220:223], v[212:215], v[72:75]
    v_lshl_add_u32 v12, v12, 9, v8
    v_xor_b32 v13, 3, v2
    v_mfma_f32_16x16x32_bf16 v[68:71], v[220:223], v[208:211], v[68:71]
    v_lshl_add_u32 v13, v13, 9, v8
    v_mfma_f32_16x16x32_bf16 v[64:67], v[220:223], v[204:207], v[64:67]
    s_waitcnt vmcnt(18)
    v_mfma_f32_16x16x32_bf16 v[64:67], a[236:239], v[128:131], v[64:67]
    v_mfma_f32_16x16x32_bf16 v[68:71], a[236:239], v[132:135], v[68:71]
    v_mfma_f32_16x16x32_bf16 v[72:75], a[236:239], v[136:139], v[72:75]
    v_mfma_f32_16x16x32_bf16 v[76:79], a[236:239], v[140:143], v[76:79]
    s_waitcnt lgkmcnt(4)
    v_mfma_f32_16x16x32_bf16 v[80:83], v[224:227], v[144:147], v[80:83]
    ds_read_b128 v[220:223], v14 offset:19456
    v_mfma_f32_16x16x32_bf16 v[84:87], v[224:227], v[148:151], v[84:87]
    v_mfma_f32_16x16x32_bf16 v[88:91], v[224:227], v[152:155], v[88:91]
    v_mul_f32 v64, v64, v66
    v_mul_f32 v65, v65, v67
    v_mfma_f32_16x16x32_bf16 v[92:95], v[224:227], v[156:159], v[92:95]
    v_mul_f32 v72, v72, v74
    v_mul_f32 v73, v73, v75
    s_waitcnt lgkmcnt(4)
    v_mfma_f32_16x16x32_bf16 v[92:95], v[228:231], v[172:175], v[92:95]
    ds_read_b128 v[224:227], v238 offset:5120
    v_mul_f32 v68, v68, v70
    v_mfma_f32_16x16x32_bf16 v[88:91], v[228:231], v[168:171], v[88:91]
    v_mul_f32 v69, v69, v71
    v_mul_f32 v76, v76, v78
    v_mfma_f32_16x16x32_bf16 v[84:87], v[228:231], v[164:167], v[84:87]
    v_mul_f32 v77, v77, v79
    v_cvt_pk_bf16_f32 v248, v64, v65
    v_mfma_f32_16x16x32_bf16 v[80:83], v[228:231], v[160:163], v[80:83]
    v_cvt_pk_bf16_f32 v250, v72, v73
    v_cvt_pk_bf16_f32 v249, v68, v69
    s_waitcnt lgkmcnt(4)
    v_mfma_f32_16x16x32_bf16 v[80:83], v[176:179], v[188:191], v[80:83]
    ds_read_b128 v[228:231], v238 offset:19456
    v_cvt_pk_bf16_f32 v251, v76, v77
    v_mfma_f32_16x16x32_bf16 v[84:87], v[176:179], v[192:195], v[84:87]
    v_permlane32_swap_b32 v248, v250
    v_permlane32_swap_b32 v249, v251
    v_mfma_f32_16x16x32_bf16 v[88:91], v[176:179], v[196:199], v[88:91]
    s_nop 0
    v_permlane16_swap_b32 v248, v249
    v_permlane16_swap_b32 v250, v251
    v_mfma_f32_16x16x32_bf16 v[92:95], v[176:179], v[200:203], v[92:95]
    global_store_dwordx4 v6, v[248:251], s[4:5] offset:-4096 sc1
    s_waitcnt lgkmcnt(4)
    v_mfma_f32_16x16x32_bf16 v[92:95], v[180:183], v[216:219], v[92:95]
    ds_read_b128 v[176:179], v14 offset:6144
    v_mfma_f32_16x16x32_bf16 v[88:91], v[180:183], v[212:215], v[88:91]
    v_mfma_f32_16x16x32_bf16 v[84:87], v[180:183], v[208:211], v[84:87]
    v_mfma_f32_16x16x32_bf16 v[80:83], v[180:183], v[204:207], v[80:83]
    s_waitcnt vmcnt(18)
    v_mfma_f32_16x16x32_bf16 v[80:83], a[240:243], v[128:131], v[80:83]
    v_mfma_f32_16x16x32_bf16 v[84:87], a[240:243], v[132:135], v[84:87]
    v_mfma_f32_16x16x32_bf16 v[88:91], a[240:243], v[136:139], v[88:91]
    v_mfma_f32_16x16x32_bf16 v[92:95], a[240:243], v[140:143], v[92:95]
    s_waitcnt lgkmcnt(4)
    v_mfma_f32_16x16x32_bf16 v[96:99], v[184:187], v[144:147], v[96:99]
    ds_read_b128 v[180:183], v14 offset:20480
    v_mfma_f32_16x16x32_bf16 v[100:103], v[184:187], v[148:151], v[100:103]
    v_mfma_f32_16x16x32_bf16 v[104:107], v[184:187], v[152:155], v[104:107]
    v_mul_f32 v80, v80, v82
    v_mul_f32 v81, v81, v83
    v_mfma_f32_16x16x32_bf16 v[108:111], v[184:187], v[156:159], v[108:111]
    v_mul_f32 v88, v88, v90
    v_mul_f32 v89, v89, v91
    s_waitcnt lgkmcnt(4)
    v_mfma_f32_16x16x32_bf16 v[108:111], v[220:223], v[172:175], v[108:111]
    ds_read_b128 v[184:187], v238 offset:6144
    v_mul_f32 v84, v84, v86
    v_mfma_f32_16x16x32_bf16 v[104:107], v[220:223], v[168:171], v[104:107]
    v_mul_f32 v85, v85, v87
    v_mul_f32 v92, v92, v94
    v_mfma_f32_16x16x32_bf16 v[100:103], v[220:223], v[164:167], v[100:103]
    v_mul_f32 v93, v93, v95
    v_cvt_pk_bf16_f32 v244, v80, v81
    v_mfma_f32_16x16x32_bf16 v[96:99], v[220:223], v[160:163], v[96:99]
    v_cvt_pk_bf16_f32 v246, v88, v89
    v_cvt_pk_bf16_f32 v245, v84, v85
    s_waitcnt lgkmcnt(4)
    v_mfma_f32_16x16x32_bf16 v[96:99], v[224:227], v[188:191], v[96:99]
    ds_read_b128 v[220:223], v238 offset:20480
    v_cvt_pk_bf16_f32 v247, v92, v93
    v_mfma_f32_16x16x32_bf16 v[100:103], v[224:227], v[192:195], v[100:103]
    v_permlane32_swap_b32 v244, v246
    v_permlane32_swap_b32 v245, v247
    v_mfma_f32_16x16x32_bf16 v[104:107], v[224:227], v[196:199], v[104:107]
    s_nop 0
    v_permlane16_swap_b32 v244, v245
    v_permlane16_swap_b32 v246, v247
    v_mfma_f32_16x16x32_bf16 v[108:111], v[224:227], v[200:203], v[108:111]
    global_store_dwordx4 v6, v[244:247], s[4:5] offset:-2048 sc1
    s_waitcnt lgkmcnt(4)
    v_mfma_f32_16x16x32_bf16 v[108:111], v[228:231], v[216:219], v[108:111]
    s_waitcnt vmcnt(2)
    s_mov_b64 exec, 1
    global_atomic_add v232, v233, s[4:5] offset:0 sc1
    s_mov_b64 exec, -1
    v_mfma_f32_16x16x32_bf16 v[104:107], v[228:231], v[212:215], v[104:107]
    v_mfma_f32_16x16x32_bf16 v[100:103], v[228:231], v[208:211], v[100:103]
    v_mfma_f32_16x16x32_bf16 v[96:99], v[228:231], v[204:207], v[96:99]
    s_waitcnt vmcnt(19)
    v_mfma_f32_16x16x32_bf16 v[96:99], a[244:247], v[128:131], v[96:99]
    v_mfma_f32_16x16x32_bf16 v[100:103], a[244:247], v[132:135], v[100:103]
    v_mfma_f32_16x16x32_bf16 v[104:107], a[244:247], v[136:139], v[104:107]
    v_mfma_f32_16x16x32_bf16 v[108:111], a[244:247], v[140:143], v[108:111]
    s_waitcnt lgkmcnt(3)
    v_mfma_f32_16x16x32_bf16 v[112:115], v[176:179], v[144:147], v[112:115]
    v_mfma_f32_16x16x32_bf16 v[116:119], v[176:179], v[148:151], v[116:119]
    v_mfma_f32_16x16x32_bf16 v[120:123], v[176:179], v[152:155], v[120:123]
    s_nop 0
    v_mul_f32 v96, v96, v98
    v_mul_f32 v97, v97, v99
    v_mfma_f32_16x16x32_bf16 v[124:127], v[176:179], v[156:159], v[124:127]
    v_mul_f32 v104, v104, v106
    v_mul_f32 v105, v105, v107
    s_waitcnt lgkmcnt(2)
    v_mfma_f32_16x16x32_bf16 v[124:127], v[180:183], v[172:175], v[124:127]
    v_mul_f32 v100, v100, v102
    v_mul_f32 v101, v101, v103
    v_mfma_f32_16x16x32_bf16 v[120:123], v[180:183], v[168:171], v[120:123]
    v_mul_f32 v108, v108, v110
    v_mul_f32 v109, v109, v111
    v_mfma_f32_16x16x32_bf16 v[116:119], v[180:183], v[164:167], v[116:119]
    v_cvt_pk_bf16_f32 v248, v96, v97
    v_cvt_pk_bf16_f32 v250, v104, v105
    v_mfma_f32_16x16x32_bf16 v[112:115], v[180:183], v[160:163], v[112:115]
    v_cvt_pk_bf16_f32 v249, v100, v101
    v_cvt_pk_bf16_f32 v251, v108, v109
    s_waitcnt lgkmcnt(1)
    v_mfma_f32_16x16x32_bf16 v[112:115], v[184:187], v[188:191], v[112:115]
    v_permlane32_swap_b32 v248, v250
    v_permlane32_swap_b32 v249, v251
    v_mfma_f32_16x16x32_bf16 v[116:119], v[184:187], v[192:195], v[116:119]
    s_nop 0
    v_permlane16_swap_b32 v248, v249
    v_permlane16_swap_b32 v250, v251
    v_mfma_f32_16x16x32_bf16 v[120:123], v[184:187], v[196:199], v[120:123]
    global_store_dwordx4 v6, v[248:251], s[4:5] offset:0 sc1
    v_mfma_f32_16x16x32_bf16 v[124:127], v[184:187], v[200:203], v[124:127]
    s_waitcnt lgkmcnt(0)
    s_barrier
    s_load_dword s1, s[4:5], s55 glc
    v_mfma_f32_16x16x32_bf16 v[124:127], v[220:223], v[216:219], v[124:127]
    v_mfma_f32_16x16x32_bf16 v[120:123], v[220:223], v[212:215], v[120:123]
    v_mfma_f32_16x16x32_bf16 v[116:119], v[220:223], v[208:211], v[116:119]
    v_mfma_f32_16x16x32_bf16 v[112:115], v[220:223], v[204:207], v[112:115]
    s_waitcnt vmcnt(19)
    v_mfma_f32_16x16x32_bf16 v[112:115], a[248:251], v[128:131], v[112:115]
    v_mfma_f32_16x16x32_bf16 v[116:119], a[248:251], v[132:135], v[116:119]
    v_mfma_f32_16x16x32_bf16 v[120:123], a[248:251], v[136:139], v[120:123]
    v_mfma_f32_16x16x32_bf16 v[124:127], a[248:251], v[140:143], v[124:127]
    s_nop 4
    v_mul_f32 v112, v112, v114
    v_mul_f32 v113, v113, v115
    v_mul_f32 v120, v120, v122
    v_mul_f32 v121, v121, v123
    v_mul_f32 v116, v116, v118
    v_mul_f32 v117, v117, v119
    v_mul_f32 v124, v124, v126
    v_mul_f32 v125, v125, v127
    v_cvt_pk_bf16_f32 v244, v112, v113
    v_cvt_pk_bf16_f32 v246, v120, v121
    v_cvt_pk_bf16_f32 v245, v116, v117
    v_cvt_pk_bf16_f32 v247, v124, v125
    v_permlane32_swap_b32 v244, v246
    s_nop 0
    v_permlane32_swap_b32 v245, v247
    s_nop 1
    v_permlane16_swap_b32 v244, v245
    v_permlane16_swap_b32 v246, v247
    global_store_dwordx4 v6, v[244:247], s[4:5] offset:2048 sc1
    s_waitcnt lgkmcnt(0)
    s_cmp_eq_u32 s1, 8
    s_cbranch_scc0 L_he_wait
    buffer_load_dwordx4 v[80:83], v10, s[36:39], s45 offen sc1
    buffer_load_dwordx4 v[84:87], v11, s[36:39], s45 offen sc1
    buffer_load_dwordx4 v[88:91], v12, s[36:39], s45 offen sc1
    buffer_load_dwordx4 v[92:95], v13, s[36:39], s45 offen sc1
    s_add_u32 s45, s45, 8192
    buffer_load_dwordx4 v[96:99], v10, s[36:39], s45 offen sc1
    buffer_load_dwordx4 v[100:103], v11, s[36:39], s45 offen sc1
    buffer_load_dwordx4 v[104:107], v12, s[36:39], s45 offen sc1
    buffer_load_dwordx4 v[108:111], v13, s[36:39], s45 offen sc1
    s_add_u32 s45, s45, 8192
    buffer_load_dwordx4 v[112:115], v10, s[36:39], s45 offen sc1
    buffer_load_dwordx4 v[116:119], v11, s[36:39], s45 offen sc1
    buffer_load_dwordx4 v[120:123], v12, s[36:39], s45 offen sc1
    buffer_load_dwordx4 v[124:127], v13, s[36:39], s45 offen sc1
    s_waitcnt vmcnt(12)
    s_mov_b64 exec, 1
    global_atomic_add v232, v233, s[4:5] offset:128 sc1
    s_mov_b64 exec, -1
    s_branch L_p2
L_he_wait:
    s_load_dword s1, s[4:5], s55 glc
L_he_seen:
    s_waitcnt vmcnt(0)
    s_mov_b64 exec, 1
    global_atomic_add v232, v233, s[4:5] offset:128 sc1
    s_mov_b64 exec, -1
    s_mov_b32 s3, 0
    s_branch L_he_t
L_he:
    s_load_dword s1, s[4:5], s55 glc
L_he_t:
    s_add_u32 s3, s3, 1
    s_cmp_gt_u32 s3, 400000
    s_waitcnt lgkmcnt(0)
    s_cbranch_scc1 L_he_x
    s_cmp_lg_u32 s1, 8
    s_cbranch_scc1 L_he
L_he_x:
    buffer_load_dwordx4 v[80:83], v10, s[36:39], s45 offen sc1
    buffer_load_dwordx4 v[84:87], v11, s[36:39], s45 offen sc1
    buffer_load_dwordx4 v[88:91], v12, s[36:39], s45 offen sc1
    buffer_load_dwordx4 v[92:95], v13, s[36:39], s45 offen sc1
    s_add_u32 s45, s45, 8192
    buffer_load_dwordx4 v[96:99], v10, s[36:39], s45 offen sc1
    buffer_load_dwordx4 v[100:103], v11, s[36:39], s45 offen sc1
    buffer_load_dwordx4 v[104:107], v12, s[36:39], s45 offen sc1
    buffer_load_dwordx4 v[108:111], v13, s[36:39], s45 offen sc1
    s_add_u32 s45, s45, 8192
    buffer_load_dwordx4 v[112:115], v10, s[36:39], s45 offen sc1
    buffer_load_dwordx4 v[116:119], v11, s[36:39], s45 offen sc1
    buffer_load_dwordx4 v[120:123], v12, s[36:39], s45 offen sc1
    buffer_load_dwordx4 v[124:127], v13, s[36:39], s45 offen sc1
L_p2:
    s_add_u32 s55, s55, 128
    s_waitcnt vmcnt(8)
    v_mfma_f32_16x16x32_bf16 v[16:19], a[0:3], v[80:83], 0
    ds_read_b64_tr_b16 a[176:177], v7 offset:57344
    v_mfma_f32_16x16x32_bf16 v[20:23], a[4:7], v[80:83], 0
    ds_read_b64_tr_b16 a[178:179], v7 offset:57856
    s_add_u32 s45, s45, 8192
    v_mfma_f32_16x16x32_bf16 v[24:27], a[8:11], v[80:83], 0
    ds_read_b64_tr_b16 a[180:181], v7 offset:57352
    buffer_load_dwordx4 v[128:131], v10, s[36:39], s45 offen sc1
    v_mfma_f32_16x16x32_bf16 v[28:31], a[12:15], v[80:83], 0
    ds_read_b64_tr_b16 a[182:183], v7 offset:57864
    v_mfma_f32_16x16x32_bf16 v[44:47], a[12:15], v[84:87], 0
    ds_read_b64_tr_b16 a[184:185], v9 offset:57344
    v_mfma_f32_16x16x32_bf16 v[40:43], a[8:11], v[84:87], 0
    ds_read_b64_tr_b16 a[186:187], v9 offset:57856
    v_mfma_f32_16x16x32_bf16 v[36:39], a[4:7], v[84:87], 0
    ds_read_b64_tr_b16 a[188:189], v9 offset:57352
    buffer_load_dwordx4 v[132:135], v11, s[36:39], s45 offen sc1
    v_mfma_f32_16x16x32_bf16 v[32:35], a[0:3], v[84:87], 0
    ds_read_b64_tr_b16 a[190:191], v9 offset:57864
    v_mfma_f32_16x16x32_bf16 v[48:51], a[0:3], v[88:91], 0
    v_mfma_f32_16x16x32_bf16 v[52:55], a[4:7], v[88:91], 0
    v_mfma_f32_16x16x32_bf16 v[56:59], a[8:11], v[88:91], 0
    buffer_load_dwordx4 v[136:139], v12, s[36:39], s45 offen sc1
    v_mfma_f32_16x16x32_bf16 v[60:63], a[12:15], v[88:91], 0
    v_mfma_f32_16x16x32_bf16 v[76:79], a[12:15], v[92:95], 0
    v_mfma_f32_16x16x32_bf16 v[72:75], a[8:11], v[92:95], 0
    v_mfma_f32_16x16x32_bf16 v[68:71], a[4:7], v[92:95], 0
    buffer_load_dwordx4 v[140:143], v13, s[36:39], s45 offen sc1
    v_mfma_f32_16x16x32_bf16 v[64:67], a[0:3], v[92:95], 0
    s_waitcnt vmcnt(8)
    v_mfma_f32_16x16x32_bf16 v[16:19], a[16:19], v[96:99], v[16:19]
    ds_read_b64_tr_b16 a[192:193], v7 offset:0
    v_mfma_f32_16x16x32_bf16 v[20:23], a[20:23], v[96:99], v[20:23]
    ds_read_b64_tr_b16 a[194:195], v7 offset:512
    s_add_u32 s45, s45, 8192
    v_mfma_f32_16x16x32_bf16 v[24:27], a[24:27], v[96:99], v[24:27]
    ds_read_b64_tr_b16 a[196:197], v7 offset:8
    buffer_load_dwordx4 v[144:147], v10, s[36:39], s45 offen sc1
    v_mfma_f32_16x16x32_bf16 v[28:31], a[28:31], v[96:99], v[28:31]
    ds_read_b64_tr_b16 a[198:199], v7 offset:520
    v_mfma_f32_16x16x32_bf16 v[44:47], a[28:31], v[100:103], v[44:47]
    ds_read_b64_tr_b16 a[200:201], v9 offset:0
    v_mfma_f32_16x16x32_bf16 v[40:43], a[24:27], v[100:103], v[40:43]
    ds_read_b64_tr_b16 a[202:203], v9 offset:512
    v_mfma_f32_16x16x32_bf16 v[36:39], a[20:23], v[100:103], v[36:39]
    ds_read_b64_tr_b16 a[204:205], v9 offset:8
    buffer_load_dwordx4 v[148:151], v11, s[36:39], s45 offen sc1
    v_mfma_f32_16x16x32_bf16 v[32:35], a[16:19], v[100:103], v[32:35]
    ds_read_b64_tr_b16 a[206:207], v9 offset:520
    v_mfma_f32_16x16x32_bf16 v[48:51], a[16:19], v[104:107], v[48:51]
    v_mfma_f32_16x16x32_bf16 v[52:55], a[20:23], v[104:107], v[52:55]
    v_mfma_f32_16x16x32_bf16 v[56:59], a[24:27], v[104:107], v[56:59]
    buffer_load_dwordx4 v[152:155], v12, s[36:39], s45 offen sc1
    v_mfma_f32_16x16x32_bf16 v[60:63], a[28:31], v[104:107], v[60:63]
    v_mfma_f32_16x16x32_bf16 v[76:79], a[28:31], v[108:111], v[76:79]
    v_mfma_f32_16x16x32_bf16 v[72:75], a[24:27], v[108:111], v[72:75]
    v_mfma_f32_16x16x32_bf16 v[68:71], a[20:23], v[108:111], v[68:71]
    buffer_load_dwordx4 v[156:159], v13, s[36:39], s45 offen sc1
    v_mfma_f32_16x16x32_bf16 v[64:67], a[16:19], v[108:111], v[64:67]
    global_load_dwordx2 v[224:225], v234, s[4:5] sc1
    s_waitcnt vmcnt(9)
    v_mfma_f32_16x16x32_bf16 v[16:19], a[32:35], v[112:115], v[16:19]
    s_load_dword s1, s[4:5], s55 glc
    v_mfma_f32_16x16x32_bf16 v[20:23], a[36:39], v[112:115], v[20:23]
    ds_read_b64_tr_b16 a[208:209], v7 offset:16384
    s_add_u32 s45, s45, 8192
    v_mfma_f32_16x16x32_bf16 v[24:27], a[40:43], v[112:115], v[24:27]
    ds_read_b64_tr_b16 a[210:211], v7 offset:16896
    buffer_load_dwordx4 v[160:163], v10, s[36:39], s45 offen sc1
    v_mfma_f32_16x16x32_bf16 v[28:31], a[44:47], v[112:115], v[28:31]
    ds_read_b64_tr_b16 a[212:213], v7 offset:16392
    v_mfma_f32_16x16x32_bf16 v[44:47], a[44:47], v[116:119], v[44:47]
    ds_read_b64_tr_b16 a[214:215], v7 offset:16904
    v_mfma_f32_16x16x32_bf16 v[40:43], a[40:43], v[116:119], v[40:43]
    ds_read_b64_tr_b16 a[216:217], v9 offset:16384
    v_mfma_f32_16x16x32_bf16 v[36:39], a[36:39], v[116:119], v[36:39]
    ds_read_b64_tr_b16 a[218:219], v9 offset:16896
    buffer_load_dwordx4 v[164:167], v11, s[36:39], s45 offen sc1
    v_mfma_f32_16x16x32_bf16 v[32:35], a[32:35], v[116:119], v[32:35]
    ds_read_b64_tr_b16 a[220:221], v9 offset:16392
    v_mfma_f32_16x16x32_bf16 v[48:51], a[32:35], v[120:123], v[48:51]
    ds_read_b64_tr_b16 a[222:223], v9 offset:16904
    v_mfma_f32_16x16x32_bf16 v[52:55], a[36:39], v[120:123], v[52:55]
T_f2_1_2:
    s_cbranch_execz T_f2_1_3
    v_mfma_f32_16x16x32_bf16 v[56:59], a[40:43], v[120:123], v[56:59]
    buffer_load_dwordx4 v[168:171], v12, s[36:39], s45 offen sc1
    v_mfma_f32_16x16x32_bf16 v[60:63], a[44:47], v[120:123], v[60:63]
    v_mfma_f32_16x16x32_bf16 v[76:79], a[44:47], v[124:127], v[76:79]
    v_mfma_f32_16x16x32_bf16 v[72:75], a[40:43], v[124:127], v[72:75]
    v_mfma_f32_16x16x32_bf16 v[68:71], a[36:39], v[124:127], v[68:71]
    buffer_load_dwordx4 v[172:175], v13, s[36:39], s45 offen sc1
    v_mfma_f32_16x16x32_bf16 v[64:67], a[32:35], v[124:127], v[64:67]
    s_waitcnt vmcnt(9) lgkmcnt(0)
    v_mfma_f32_16x16x32_bf16 v[16:19], a[48:51], v[128:131], v[16:19]
    s_mov_b32 s3, 0
    s_branch L_hl_t
L_hl:
    s_load_dword s1, s[4:5], s55 glc
L_hl_t:
    s_add_u32 s3, s3, 1
    s_cmp_gt_u32 s3, 400000
    s_waitcnt lgkmcnt(0)
    s_cbranch_scc1 L_hl_x
    s_cmp_lg_u32 s1, 8
    s_cbranch_scc1 L_hl
L_hl_x:
    v_mfma_f32_16x16x32_bf16 v[20:23], a[52:55], v[128:131], v[20:23]
    s_add_u32 s45, s45, 8192
    v_mfma_f32_16x16x32_bf16 v[24:27], a[56:59], v[128:131], v[24:27]
    buffer_load_dwordx4 v[176:179], v10, s[36:39], s45 offen sc1
    v_mfma_f32_16x16x32_bf16 v[28:31], a[60:63], v[128:131], v[28:31]
    v_mfma_f32_16x16x32_bf16 v[44:47], a[60:63], v[132:135], v[44:47]
    v_mfma_f32_16x16x32_bf16 v[40:43], a[56:59], v[132:135], v[40:43]
    v_mfma_f32_16x16x32_bf16 v[36:39], a[52:55], v[132:135], v[36:39]
T_f2_1_3:
    s_cbranch_execz T_f2_back
    buffer_load_dwordx4 v[180:183], v11, s[36:39], s45 offen sc1
    v_mfma_f32_16x16x32_bf16 v[32:35], a[48:51], v[132:135], v[32:35]
    v_mfma_f32_16x16x32_bf16 v[48:51], a[48:51], v[136:139], v[48:51]
    v_mfma_f32_16x16x32_bf16 v[52:55], a[52:55], v[136:139], v[52:55]
    v_mfma_f32_16x16x32_bf16 v[56:59], a[56:59], v[136:139], v[56:59]
    buffer_load_dwordx4 v[184:187], v12, s[36:39], s45 offen sc1
    v_mfma_f32_16x16x32_bf16 v[60:63], a[60:63], v[136:139], v[60:63]
    v_mfma_f32_16x16x32_bf16 v[76:79], a[60:63], v[140:143], v[76:79]
    v_mfma_f32_16x16x32_bf16 v[72:75], a[56:59], v[140:143], v[72:75]
    v_mfma_f32_16x16x32_bf16 v[68:71], a[52:55], v[140:143], v[68:71]
    buffer_load_dwordx4 v[188:191], v13, s[36:39], s45 offen sc1
    v_mfma_f32_16x16x32_bf16 v[64:67], a[48:51], v[140:143], v[64:67]
    s_waitcnt vmcnt(9)
    v_mfma_f32_16x16x32_bf16 v[16:19], a[64:67], v[144:147], v[16:19]
    v_mfma_f32_16x16x32_bf16 v[20:23], a[68:71], v[144:147], v[20:23]
    s_add_u32 s45, s45, 8192
    v_mfma_f32_16x16x32_bf16 v[24:27], a[72:75], v[144:147], v[24:27]
    buffer_load_dwordx4 v[80:83], v10, s[36:39], s45 offen sc1
    v_mfma_f32_16x16x32_bf16 v[28:31], a[76:79], v[144:147], v[28:31]
    v_mfma_f32_16x16x32_bf16 v[44:47], a[76:79], v[148:151], v[44:47]
    v_mfma_f32_16x16x32_bf16 v[40:43], a[72:75], v[148:151], v[40:43]
    v_mfma_f32_16x16x32_bf16 v[36:39], a[68:71], v[148:151], v[36:39]
    buffer_load_dwordx4 v[84:87], v11, s[36:39], s45 offen sc1
    v_mfma_f32_16x16x32_bf16 v[32:35], a[64:67], v[148:151], v[32:35]
    v_mfma_f32_16x16x32_bf16 v[48:51], a[64:67], v[152:155], v[48:51]
    v_mfma_f32_16x16x32_bf16 v[52:55], a[68:71], v[152:155], v[52:55]
    v_mfma_f32_16x16x32_bf16 v[56:59], a[72:75], v[152:155], v[56:59]
    buffer_load_dwordx4 v[88:91], v12, s[36:39], s45 offen sc1
    v_mfma_f32_16x16x32_bf16 v[60:63], a[76:79], v[152:155], v[60:63]
    v_mfma_f32_16x16x32_bf16 v[76:79], a[76:79], v[156:159], v[76:79]
    v_mfma_f32_16x16x32_bf16 v[72:75], a[72:75], v[156:159], v[72:75]
    v_mfma_f32_16x16x32_bf16 v[68:71], a[68:71], v[156:159], v[68:71]
    buffer_load_dwordx4 v[92:95], v13, s[36:39], s45 offen sc1
    v_mfma_f32_16x16x32_bf16 v[64:67], a[64:67], v[156:159], v[64:67]
    s_waitcnt vmcnt(8)
    v_mfma_f32_16x16x32_bf16 v[16:19], a[80:83], v[160:163], v[16:19]
    v_mfma_f32_16x16x32_bf16 v[20:23], a[84:87], v[160:163], v[20:23]
    s_add_u32 s45, s45, 8192
    v_mfma_f32_16x16x32_bf16 v[24:27], a[88:91], v[160:163], v[24:27]
    buffer_load_dwordx4 v[96:99], v10, s[36:39], s45 offen sc1
    v_mfma_f32_16x16x32_bf16 v[28:31], a[92:95], v[160:163], v[28:31]
    v_mfma_f32_16x16x32_bf16 v[44:47], a[92:95], v[164:167], v[44:47]
    v_mfma_f32_16x16x32_bf16 v[40:43], a[88:91], v[164:167], v[40:43]
    v_mfma_f32_16x16x32_bf16 v[36:39], a[84:87], v[164:167], v[36:39]
    buffer_load_dwordx4 v[100:103], v11, s[36:39], s45 offen sc1
    v_mfma_f32_16x16x32_bf16 v[32:35], a[80:83], v[164:167], v[32:35]
    v_mfma_f32_16x16x32_bf16 v[48:51], a[80:83], v[168:171], v[48:51]
    v_mfma_f32_16x16x32_bf16 v[52:55], a[84:87], v[168:171], v[52:55]
    v_mfma_f32_16x16x32_bf16 v[56:59], a[88:91], v[168:171], v[56:59]
    buffer_load_dwordx4 v[104:107], v12, s[36:39], s45 offen sc1
    v_mfma_f32_16x16x32_bf16 v[60:63], a[92:95], v[168:171], v[60:63]
    v_mfma_f32_16x16x32_bf16 v[76:79], a[92:95], v[172:175], v[76:79]
    v_mfma_f32_16x16x32_bf16 v[72:75], a[88:91], v[172:175], v[72:75]
    v_mfma_f32_16x16x32_bf16 v[68:71], a[84:87], v[172:175], v[68:71]
    buffer_load_dwordx4 v[108:111], v13, s[36:39], s45 offen sc1
    v_mfma_f32_16x16x32_bf16 v[64:67], a[80:83], v[172:175], v[64:67]
    s_waitcnt vmcnt(8)
    v_mfma_f32_16x16x32_bf16 v[16:19], a[96:99], v[176:179], v[16:19]
    v_mfma_f32_16x16x32_bf16 v[20:23], a[100:103], v[176:179], v[20:23]
    s_add_u32 s45, s45, 8192
    v_mfma_f32_16x16x32_bf16 v[24:27], a[104:107], v[176:179], v[24:27]
    buffer_load_dwordx4 v[112:115], v10, s[36:39], s45 offen sc1
    v_mfma_f32_16x16x32_bf16 v[28:31], a[108:111], v[176:179], v[28:31]
    v_mfma_f32_16x16x32_bf16 v[44:47], a[108:111], v[180:183], v[44:47]
    v_mfma_f32_16x16x32_bf16 v[40:43], a[104:107], v[180:183], v[40:43]
    v_mfma_f32_16x16x32_bf16 v[36:39], a[100:103], v[180:183], v[36:39]
    buffer_load_dwordx4 v[116:119], v11, s[36:39], s45 offen sc1
    v_mfma_f32_16x16x32_bf16 v[32:35], a[96:99], v[180:183], v[32:35]
    v_mfma_f32_16x16x32_bf16 v[48:51], a[96:99], v[184:187], v[48:51]
    v_mfma_f32_16x16x32_bf16 v[52:55], a[100:103], v[184:187], v[52:55]
    v_mfma_f32_16x16x32_bf16 v[56:59], a[104:107], v[184:187], v[56:59]
    buffer_load_dwordx4 v[120:123], v12, s[36:39], s45 offen sc1
    v_mfma_f32_16x16x32_bf16 v[60:63], a[108:111], v[184:187], v[60:63]
    v_mfma_f32_16x16x32_bf16 v[76:79], a[108:111], v[188:191], v[76:79]
    v_mfma_f32_16x16x32_bf16 v[72:75], a[104:107], v[188:191], v[72:75]
    v_mfma_f32_16x16x32_bf16 v[68:71], a[100:103], v[188:191], v[68:71]
    buffer_load_dwordx4 v[124:127], v13, s[36:39], s45 offen sc1
    v_mfma_f32_16x16x32_bf16 v[64:67], a[96:99], v[188:191], v[64:67]
    s_waitcnt vmcnt(8)
    v_mfma_f32_16x16x32_bf16 v[16:19], a[112:115], v[80:83], v[16:19]
    s_waitcnt vmcnt(20)
    v_mfma_f32_16x16x32_bf16 v[20:23], a[116:119], v[80:83], v[20:23]
    s_add_u32 s45, s45, 8192
    v_mfma_f32_16x16x32_bf16 v[24:27], a[120:123], v[80:83], v[24:27]
    buffer_load_dwordx4 v[128:131], v10, s[36:39], s45 offen sc1
    v_mfma_f32_16x16x32_bf16 v[28:31], a[124:127], v[80:83], v[28:31]
    v_mov_b32 v226, v224
    v_mov_b32 v227, v225
    v_mfma_f32_16x16x32_bf16 v[44:47], a[124:127], v[84:87], v[44:47]
    v_permlane16_swap_b32 v224, v226
    v_mfma_f32_16x16x32_bf16 v[40:43], a[120:123], v[84:87], v[40:43]
    v_permlane16_swap_b32 v225, v227
    v_mfma_f32_16x16x32_bf16 v[36:39], a[116:119], v[84:87], v[36:39]
    buffer_load_dwordx4 v[132:135], v11, s[36:39], s45 offen sc1
    v_mfma_f32_16x16x32_bf16 v[32:35], a[112:115], v[84:87], v[32:35]
    v_add_f32 v224, v224, v226
    v_mfma_f32_16x16x32_bf16 v[48:51], a[112:115], v[88:91], v[48:51]
    v_add_f32 v225, v225, v227
    v_mfma_f32_16x16x32_bf16 v[52:55], a[116:119], v[88:91], v[52:55]
    v_mov_b32 v226, v224
    v_mfma_f32_16x16x32_bf16 v[56:59], a[120:123], v[88:91], v[56:59]
    buffer_load_dwordx4 v[136:139], v12, s[36:39], s45 offen sc1
    v_mfma_f32_16x16x32_bf16 v[60:63], a[124:127], v[88:91], v[60:63]
    v_mov_b32 v227, v225
    v_permlane32_swap_b32 v224, v226
    v_mfma_f32_16x16x32_bf16 v[76:79], a[124:127], v[92:95], v[76:79]
    v_permlane32_swap_b32 v225, v227
    v_mfma_f32_16x16x32_bf16 v[72:75], a[120:123], v[92:95], v[72:75]
    v_add_f32 v224, v224, v226
    v_mfma_f32_16x16x32_bf16 v[68:71], a[116:119], v[92:95], v[68:71]
    buffer_load_dwordx4 v[140:143], v13, s[36:39], s45 offen sc1
    v_mfma_f32_16x16x32_bf16 v[64:67], a[112:115], v[92:95], v[64:67]
    v_add_f32 v225, v225, v227
    s_waitcnt vmcnt(8)
    v_mfma_f32_16x16x32_bf16 v[16:19], a[128:131], v[96:99], v[16:19]
    v_mul_f32 v224, 0xbb000000, v224
    v_mul_f32 v225, 0xbb000000, v225
    v_mfma_f32_16x16x32_bf16 v[20:23], a[132:135], v[96:99], v[20:23]
    s_add_u32 s45, s45, 8192
    v_fma_f32 v225, -v224, v224, v225
    v_mfma_f32_16x16x32_bf16 v[24:27], a[136:139], v[96:99], v[24:27]
    buffer_load_dwordx4 v[144:147], v10, s[36:39], s45 offen sc1
    v_mfma_f32_16x16x32_bf16 v[28:31], a[140:143], v[96:99], v[28:31]
    v_max_f32 v225, 0, v225
    v_add_f32 v225, 0x3727c5ac, v225
    v_mfma_f32_16x16x32_bf16 v[44:47], a[140:143], v[100:103], v[44:47]
    v_rcp_f32 v226, v225
    v_bfe_u32 v15, v1, 2, 2
    v_mfma_f32_16x16x32_bf16 v[40:43], a[136:139], v[100:103], v[40:43]
    v_xor_b32 v14, s22, v15
    v_lshlrev_b32 v14, 5, v14
    v_mfma_f32_16x16x32_bf16 v[36:39], a[132:135], v[100:103], v[36:39]
    buffer_load_dwordx4 v[148:151], v11, s[36:39], s45 offen sc1
    v_mfma_f32_16x16x32_bf16 v[32:35], a[128:131], v[100:103], v[32:35]
    v_lshl_add_u32 v15, v4, 3, v15
    v_lshl_add_u32 v14, v15, 7, v14
    v_mfma_f32_16x16x32_bf16 v[48:51], a[128:131], v[104:107], v[48:51]
    v_and_b32 v15, 3, v1
    v_lshl_add_u32 v14, v15, 3, v14
    v_mfma_f32_16x16x32_bf16 v[52:55], a[132:135], v[104:107], v[52:55]
    v_add_u32 v14, 139264, v14
    s_lshl_b32 s20, s34, 6
    v_mfma_f32_16x16x32_bf16 v[56:59], a[136:139], v[104:107], v[56:59]
    buffer_load_dwordx4 v[152:155], v12, s[36:39], s45 offen sc1
    v_mfma_f32_16x16x32_bf16 v[60:63], a[140:143], v[104:107], v[60:63]
    s_lshl_b32 s21, s22, 4
    s_add_u32 s20, s20, s21
    v_mfma_f32_16x16x32_bf16 v[76:79], a[140:143], v[108:111], v[76:79]
    s_lshl_b32 s20, s20, 10
    s_lshl_b32 s21, s35, 7
    v_mfma_f32_16x16x32_bf16 v[72:75], a[136:139], v[108:111], v[72:75]
    s_add_u32 s20, s20, s21
    v_lshlrev_b32 v15, 10, v3
    v_mfma_f32_16x16x32_bf16 v[68:71], a[132:135], v[108:111], v[68:71]
    buffer_load_dwordx4 v[156:159], v13, s[36:39], s45 offen sc1
    v_mfma_f32_16x16x32_bf16 v[64:67], a[128:131], v[108:111], v[64:67]
    v_lshl_add_u32 v15, v4, 4, v15
    v_add_u32 v15, s20, v15
    s_waitcnt vmcnt(8)
    v_mfma_f32_16x16x32_bf16 v[16:19], a[144:147], v[112:115], v[16:19]
    ds_read_b64_tr_b16 v[192:193], v14 offset:0
    v_mfma_f32_16x16x32_bf16 v[20:23], a[148:151], v[112:115], v[20:23]
    s_add_u32 s45, s45, 8192
    v_mfma_f32_16x16x32_bf16 v[24:27], a[152:155], v[112:115], v[24:27]
    buffer_load_dwordx4 v[160:163], v10, s[36:39], s45 offen sc1
    v_mfma_f32_16x16x32_bf16 v[28:31], a[156:159], v[112:115], v[28:31]
    v_mfma_f32_16x16x32_bf16 v[44:47], a[156:159], v[116:119], v[44:47]
    v_mfma_f32_16x16x32_bf16 v[40:43], a[152:155], v[116:119], v[40:43]
    v_mfma_f32_16x16x32_bf16 v[36:39], a[148:151], v[116:119], v[36:39]
    buffer_load_dwordx4 v[164:167], v11, s[36:39], s45 offen sc1
    v_mfma_f32_16x16x32_bf16 v[32:35], a[144:147], v[116:119], v[32:35]
    ds_read_b64_tr_b16 v[194:195], v14 offset:512
    v_mfma_f32_16x16x32_bf16 v[48:51], a[144:147], v[120:123], v[48:51]
    v_mfma_f32_16x16x32_bf16 v[52:55], a[148:151], v[120:123], v[52:55]
    ds_read_b64_tr_b16 v[196:197], v14 offset:4096
    v_mfma_f32_16x16x32_bf16 v[56:59], a[152:155], v[120:123], v[56:59]
    buffer_load_dwordx4 v[168:171], v12, s[36:39], s45 offen sc1
    v_mfma_f32_16x16x32_bf16 v[60:63], a[156:159], v[120:123], v[60:63]
    v_mfma_f32_16x16x32_bf16 v[76:79], a[156:159], v[124:127], v[76:79]
    v_mfma_f32_16x16x32_bf16 v[72:75], a[152:155], v[124:127], v[72:75]
    ds_read_b64_tr_b16 v[198:199], v14 offset:4608
    v_mfma_f32_16x16x32_bf16 v[68:71], a[148:151], v[124:127], v[68:71]
    buffer_load_dwordx4 v[172:175], v13, s[36:39], s45 offen sc1
    v_mfma_f32_16x16x32_bf16 v[64:67], a[144:147], v[124:127], v[64:67]
    s_waitcnt vmcnt(8)
    v_mfma_f32_16x16x32_bf16 v[16:19], a[160:163], v[128:131], v[16:19]
    s_waitcnt lgkmcnt(0)
    v_mfma_f32_16x16x32_bf16 v[20:23], a[164:167], v[128:131], v[20:23]
    s_add_u32 s45, s45, 8192
    v_lshlrev_b32 v200, 16, v192
    v_mfma_f32_16x16x32_bf16 v[24:27], a[168:171], v[128:131], v[24:27]
    buffer_load_dwordx4 v[176:179], v10, s[36:39], s45 offen sc1
    v_mfma_f32_16x16x32_bf16 v[28:31], a[172:175], v[128:131], v[28:31]
    v_and_b32 v201, 0xffff0000, v192
    v_lshlrev_b32 v202, 16, v193
    v_mfma_f32_16x16x32_bf16 v[44:47], a[172:175], v[132:135], v[44:47]
    v_and_b32 v203, 0xffff0000, v193
    v_mfma_f32_16x16x32_bf16 v[40:43], a[168:171], v[132:135], v[40:43]
    v_lshlrev_b32 v204, 16, v194
    v_mfma_f32_16x16x32_bf16 v[36:39], a[164:167], v[132:135], v[36:39]
    buffer_load_dwordx4 v[180:183], v11, s[36:39], s45 offen sc1
    v_and_b32 v205, 0xffff0000, v194
    v_mfma_f32_16x16x32_bf16 v[32:35], a[160:163], v[132:135], v[32:35]
    v_lshlrev_b32 v206, 16, v195
    v_mfma_f32_16x16x32_bf16 v[48:51], a[160:163], v[136:139], v[48:51]
    v_and_b32 v207, 0xffff0000, v195
    v_mfma_f32_16x16x32_bf16 v[52:55], a[164:167], v[136:139], v[52:55]
    v_lshlrev_b32 v208, 16, v196
    v_and_b32 v209, 0xffff0000, v196
    v_mfma_f32_16x16x32_bf16 v[56:59], a[168:171], v[136:139], v[56:59]
    buffer_load_dwordx4 v[184:187], v12, s[36:39], s45 offen sc1
    v_mfma_f32_16x16x32_bf16 v[60:63], a[172:175], v[136:139], v[60:63]
    v_lshlrev_b32 v210, 16, v197
    v_and_b32 v211, 0xffff0000, v197
    v_mfma_f32_16x16x32_bf16 v[76:79], a[172:175], v[140:143], v[76:79]
    v_lshlrev_b32 v212, 16, v198
    v_mfma_f32_16x16x32_bf16 v[72:75], a[168:171], v[140:143], v[72:75]
    v_and_b32 v213, 0xffff0000, v198
    v_mfma_f32_16x16x32_bf16 v[68:71], a[164:167], v[140:143], v[68:71]
    buffer_load_dwordx4 v[188:191], v13, s[36:39], s45 offen sc1
    v_lshlrev_b32 v214, 16, v199
    v_mfma_f32_16x16x32_bf16 v[64:67], a[160:163], v[140:143], v[64:67]
    v_and_b32 v215, 0xffff0000, v199
    s_waitcnt vmcnt(8)
    v_mfma_f32_16x16x32_bf16 v[16:19], a[176:179], v[144:147], v[16:19]
    v_lshl_add_u32 v9, v1, 4, s24
    v_mfma_f32_16x16x32_bf16 v[20:23], a[180:183], v[144:147], v[20:23]
    v_mfma_f32_16x16x32_bf16 v[24:27], a[184:187], v[144:147], v[24:27]
    global_load_dwordx4 v[240:243], v235, s[4:5] offset:0 sc1
    v_mfma_f32_16x16x32_bf16 v[28:31], a[188:191], v[144:147], v[28:31]
    v_mfma_f32_16x16x32_bf16 v[44:47], a[188:191], v[148:151], v[44:47]
    v_xor_b32 v5, 4096, v9
    v_mfma_f32_16x16x32_bf16 v[40:43], a[184:187], v[148:151], v[40:43]
    v_mfma_f32_16x16x32_bf16 v[36:39], a[180:183], v[148:151], v[36:39]
    global_load_dwordx4 v[244:247], v235, s[4:5] offset:16 sc1
    v_mfma_f32_16x16x32_bf16 v[32:35], a[176:179], v[148:151], v[32:35]
    v_mfma_f32_16x16x32_bf16 v[48:51], a[176:179], v[152:155], v[48:51]
    v_xor_b32 v6, 8192, v9
    v_mfma_f32_16x16x32_bf16 v[52:55], a[180:183], v[152:155], v[52:55]
    v_mfma_f32_16x16x32_bf16 v[56:59], a[184:187], v[152:155], v[56:59]
    global_load_dwordx4 v[248:251], v235, s[4:5] offset:128 sc1
    v_mfma_f32_16x16x32_bf16 v[60:63], a[188:191], v[152:155], v[60:63]
    v_mfma_f32_16x16x32_bf16 v[76:79], a[188:191], v[156:159], v[76:79]
    v_xor_b32 v7, 12288, v9
    v_mfma_f32_16x16x32_bf16 v[72:75], a[184:187], v[156:159], v[72:75]
    v_mfma_f32_16x16x32_bf16 v[68:71], a[180:183], v[156:159], v[68:71]
    global_load_dwordx4 v[252:255], v235, s[4:5] offset:144 sc1
    v_mfma_f32_16x16x32_bf16 v[64:67], a[176:179], v[156:159], v[64:67]
    s_waitcnt vmcnt(8)
    v_mfma_f32_16x16x32_bf16 v[32:35], a[192:195], v[164:167], v[32:35]
    v_mfma_f32_16x16x32_bf16 v[36:39], a[196:199], v[164:167], v[36:39]
    v_mfma_f32_16x16x32_bf16 v[40:43], a[200:203], v[164:167], v[40:43]
    v_mfma_f32_16x16x32_bf16 v[44:47], a[204:207], v[164:167], v[44:47]
    v_mfma_f32_16x16x32_bf16 v[60:63], a[204:207], v[168:171], v[60:63]
    v_mfma_f32_16x16x32_bf16 v[56:59], a[200:203], v[168:171], v[56:59]
    v_mfma_f32_16x16x32_bf16 v[52:55], a[196:199], v[168:171], v[52:55]
    v_mfma_f32_16x16x32_bf16 v[48:51], a[192:195], v[168:171], v[48:51]
    v_mfma_f32_16x16x32_bf16 v[64:67], a[192:195], v[172:175], v[64:67]
    v_mfma_f32_16x16x32_bf16 v[68:71], a[196:199], v[172:175], v[68:71]
    v_mfma_f32_16x16x32_bf16 v[72:75], a[200:203], v[172:175], v[72:75]
    v_mfma_f32_16x16x32_bf16 v[76:79], a[204:207], v[172:175], v[76:79]
    s_waitcnt vmcnt(4)
    v_mfma_f32_16x16x32_bf16 v[32:35], a[208:211], v[180:183], v[32:35]
    v_mfma_f32_16x16x32_bf16 v[36:39], a[212:215], v[180:183], v[36:39]
    v_mfma_f32_16x16x32_bf16 v[40:43], a[216:219], v[180:183], v[40:43]
    v_mfma_f32_16x16x32_bf16 v[44:47], a[220:223], v[180:183], v[44:47]
    v_mfma_f32_16x16x32_bf16 v[60:63], a[220:223], v[184:187], v[60:63]
    v_mfma_f32_16x16x32_bf16 v[56:59], a[216:219], v[184:187], v[56:59]
    v_mfma_f32_16x16x32_bf16 v[52:55], a[212:215], v[184:187], v[52:55]
    v_mfma_f32_16x16x32_bf16 v[48:51], a[208:211], v[184:187], v[48:51]
    s_nop 0
    ds_write_b128 v9, v[32:35] offset:0
    v_mfma_f32_16x16x32_bf16 v[64:67], a[208:211], v[188:191], v[64:67]
    ds_write_b128 v9, v[36:39] offset:1024
    v_mfma_f32_16x16x32_bf16 v[68:71], a[212:215], v[188:191], v[68:71]
    ds_write_b128 v9, v[40:43] offset:2048
    v_mfma_f32_16x16x32_bf16 v[72:75], a[216:219], v[188:191], v[72:75]
    ds_write_b128 v9, v[44:47] offset:3072
    v_mfma_f32_16x16x32_bf16 v[76:79], a[220:223], v[188:191], v[76:79]
    ds_write_b128 v9, v[60:63] offset:19456
    v_mfma_f32_16x16x32_bf16 v[28:31], a[204:207], v[160:163], v[28:31]
    ds_write_b128 v9, v[56:59] offset:18432
    v_mfma_f32_16x16x32_bf16 v[24:27], a[200:203], v[160:163], v[24:27]
    ds_write_b128 v9, v[52:55] offset:17408
    v_mfma_f32_16x16x32_bf16 v[20:23], a[196:199], v[160:163], v[20:23]
    ds_write_b128 v9, v[48:51] offset:16384
    v_mfma_f32_16x16x32_bf16 v[16:19], a[192:195], v[160:163], v[16:19]
    ds_write_b128 v9, v[64:67] offset:32768
    v_mfma_f32_16x16x32_bf16 v[28:31], a[220:223], v[176:179], v[28:31]
    ds_write_b128 v9, v[68:71] offset:33792
    v_mfma_f32_16x16x32_bf16 v[24:27], a[216:219], v[176:179], v[24:27]
    ds_write_b128 v9, v[72:75] offset:34816
    v_mfma_f32_16x16x32_bf16 v[20:23], a[212:215], v[176:179], v[20:23]
    ds_write_b128 v9, v[76:79] offset:35840
    v_mfma_f32_16x16x32_bf16 v[16:19], a[208:211], v[176:179], v[16:19]
    s_waitcnt vmcnt(0)
    v_pk_mul_f32 v[240:241], v[240:241], v[226:227] op_sel_hi:[1,0]
    v_pk_mul_f32 v[242:243], v[242:243], v[226:227] op_sel_hi:[1,0]
    v_pk_mul_f32 v[244:245], v[244:245], v[226:227] op_sel_hi:[1,0]
    v_pk_mul_f32 v[246:247], v[246:247], v[226:227] op_sel_hi:[1,0]
    v_pk_mul_f32 v[248:249], v[248:249], v[226:227] op_sel_hi:[1,0]
    v_pk_mul_f32 v[250:251], v[250:251], v[226:227] op_sel_hi:[1,0]
    v_pk_mul_f32 v[252:253], v[252:253], v[226:227] op_sel_hi:[1,0]
    v_pk_mul_f32 v[254:255], v[254:255], v[226:227] op_sel_hi:[1,0]
    s_waitcnt lgkmcnt(0)
    s_barrier
    ds_read_b128 v[32:35], v5 offset:0
    ds_read_b128 v[36:39], v5 offset:1024
    ds_read_b128 v[48:51], v6 offset:16384
    ds_read_b128 v[52:55], v6 offset:17408
    ds_read_b128 v[64:67], v7 offset:32768
    ds_read_b128 v[68:71], v7 offset:33792
    ds_read_b128 v[40:43], v5 offset:2048
    ds_read_b128 v[44:47], v5 offset:3072
    ds_read_b128 v[56:59], v6 offset:18432
    ds_read_b128 v[60:63], v6 offset:19456
    ds_read_b128 v[72:75], v7 offset:34816
    ds_read_b128 v[76:79], v7 offset:35840
    s_waitcnt lgkmcnt(10)
    v_pk_add_f32 v[16:17], v[16:17], v[32:33]
    v_pk_add_f32 v[18:19], v[18:19], v[34:35]
    v_pk_add_f32 v[20:21], v[20:21], v[36:37]
    v_pk_add_f32 v[22:23], v[22:23], v[38:39]
    s_waitcnt lgkmcnt(8)
    v_pk_add_f32 v[16:17], v[16:17], v[48:49]
    v_pk_add_f32 v[18:19], v[18:19], v[50:51]
    v_pk_add_f32 v[20:21], v[20:21], v[52:53]
    v_pk_add_f32 v[22:23], v[22:23], v[54:55]
    s_waitcnt lgkmcnt(6)
    v_pk_add_f32 v[16:17], v[16:17], v[64:65]
    v_pk_add_f32 v[18:19], v[18:19], v[66:67]
    v_pk_add_f32 v[20:21], v[20:21], v[68:69]
    v_pk_add_f32 v[22:23], v[22:23], v[70:71]
    v_pk_fma_f32 v[16:17], v[16:17], v[240:241], v[200:201]
    v_pk_fma_f32 v[18:19], v[18:19], v[242:243], v[202:203]
    v_pk_fma_f32 v[20:21], v[20:21], v[244:245], v[204:205]
    v_pk_fma_f32 v[22:23], v[22:23], v[246:247], v[206:207]
    v_cvt_pk_bf16_f32 v120, v16, v17
    v_cvt_pk_bf16_f32 v121, v18, v19
    v_cvt_pk_bf16_f32 v122, v20, v21
    v_cvt_pk_bf16_f32 v123, v22, v23
    global_store_dwordx4 v15, v[120:123], s[6:7] offset:0 sc1
    s_waitcnt lgkmcnt(4)
    v_pk_add_f32 v[24:25], v[24:25], v[40:41]
    v_pk_add_f32 v[26:27], v[26:27], v[42:43]
    v_pk_add_f32 v[28:29], v[28:29], v[44:45]
    v_pk_add_f32 v[30:31], v[30:31], v[46:47]
    s_waitcnt lgkmcnt(2)
    v_pk_add_f32 v[24:25], v[24:25], v[56:57]
    v_pk_add_f32 v[26:27], v[26:27], v[58:59]
    v_pk_add_f32 v[28:29], v[28:29], v[60:61]
    v_pk_add_f32 v[30:31], v[30:31], v[62:63]
    s_waitcnt lgkmcnt(0)
    v_pk_add_f32 v[24:25], v[24:25], v[72:73]
    v_pk_add_f32 v[26:27], v[26:27], v[74:75]
    v_pk_add_f32 v[28:29], v[28:29], v[76:77]
    v_pk_add_f32 v[30:31], v[30:31], v[78:79]
    v_pk_fma_f32 v[24:25], v[24:25], v[248:249], v[208:209]
    v_pk_fma_f32 v[26:27], v[26:27], v[250:251], v[210:211]
    v_pk_fma_f32 v[28:29], v[28:29], v[252:253], v[212:213]
    v_pk_fma_f32 v[30:31], v[30:31], v[254:255], v[214:215]
    v_cvt_pk_bf16_f32 v124, v24, v25
    v_cvt_pk_bf16_f32 v125, v26, v27
    v_cvt_pk_bf16_f32 v126, v28, v29
    v_cvt_pk_bf16_f32 v127, v30, v31
    global_store_dwordx4 v15, v[124:127], s[6:7] offset:64 sc1
L_end:
    s_endpgm
L_retry:
    s_mov_b32 s3, 0
L_retry2:
    global_load_dwordx2 v[128:129], v255, s[4:5] offset:0 sc1
    global_load_dwordx2 v[130:131], v255, s[4:5] offset:128 sc1
    global_load_dwordx2 v[132:133], v255, s[4:5] offset:512 sc1
    global_load_dwordx2 v[134:135], v255, s[4:5] offset:640 sc1
    s_add_u32 s3, s3, 1
    s_cmp_gt_u32 s3, 400000
    s_waitcnt vmcnt(0)
    s_cbranch_scc1 L_ok
    v_and_b32 v232, v129, v131
    v_and_b32 v233, v133, v135
    v_and_b32 v232, v232, v233
    v_cmp_le_i32 vcc, 0, v232
    s_nop 0
    s_cbranch_vccnz L_retry2
    s_branch L_ok
L_code_end:
.fill (32768 + 64 - (L_code_end - L_body)) / 4, 4, 0xbf810000
.section .rodata,"a"
.p2align 6
.amdhsa_kernel adaLN_cond__ssm_conv_s4__glu_gated_bilinear__prompt_kernel
  .amdhsa_next_free_vgpr 508
  .amdhsa_next_free_sgpr 64
  .amdhsa_accum_offset 256
  .amdhsa_group_segment_fixed_size 0
  .amdhsa_kernarg_size 144
  .amdhsa_user_sgpr_count 2
  .amdhsa_user_sgpr_kernarg_segment_ptr 1
  .amdhsa_system_sgpr_workgroup_id_x 1
.end_amdhsa_kernel
```
